```python
import torch

def _softmax(x, axis=-1):
    return torch.softmax(x, dim=axis)
def _gelu(x):
    return torch.nn.functional.gelu(x, approximate="tanh")
def _silu(x):
    return torch.nn.functional.silu(x)
def _sigmoid(x):
    return torch.sigmoid(x)
def _layernorm(x, axis=-1, eps=1e-5):
    m = x.mean(dim=axis, keepdim=True)
    v = x.var(dim=axis, keepdim=True, unbiased=False)
    return (x - m) / torch.sqrt(v + eps)
def _scatter_add(tgt, idx, src, axis=0):
    return tgt.clone().index_add_(axis, idx, src)
def _segment_sum(src, seg, n):
    out = torch.zeros((n,) + src.shape[1:], dtype=src.dtype)
    return out.index_add_(0, seg, src)
def _pad(x, pw):
    flat = tuple(v for pair in reversed(pw) for v in pair)
    return torch.nn.functional.pad(x, flat)

kernel_name = 'parallel_sum__compressed_kv_cla__glu_gated_bilinear__decode'

def setup_inputs():

    _w = (lambda a: (lambda t: t.to(torch.bfloat16) if t.is_floating_point() else t)(torch.as_tensor(a)))
    def _A_setup():
        B, H, Sq, Sk, D, M = 2, 32, 1, 8192, 128, 512
        Dc = 4 * D
        return {
            "x": _w((lambda *s: torch.randn(*s, dtype=torch.bfloat16) * 0.05)(B, Sq, M)),
            "c_kv": _w((lambda *s: torch.randn(*s, dtype=torch.bfloat16) * 0.8)(B, Sk, Dc)),
            "w_q": _w((lambda *s: torch.randn(*s, dtype=torch.bfloat16) * 1.6)(M, H, D) * (M ** -0.5)),
            "w_uk": _w((lambda *s: torch.randn(*s, dtype=torch.bfloat16) * 1.6)(Dc, H, D) * (Dc ** -0.5)),
            "w_uv": _w((lambda *s: torch.randn(*s, dtype=torch.bfloat16) * 0.8)(Dc, H, D) * (Dc ** -0.5)),
            "w_o": _w((lambda *s: torch.randn(*s, dtype=torch.bfloat16) * 0.8)(H, D, M) * ((H * D) ** -0.5)),
        }
    _A_in = _A_setup()

    def _B_setup():
        B, S, D, F = 2, 1, 512, 1792
        return {
            "x": _w((lambda *s: torch.randn(*s, dtype=torch.bfloat16) * 0.05)(B, S, D)),
            "w_gate": _w((lambda *s: torch.randn(*s, dtype=torch.bfloat16) * 0.4)(D, F) * (D ** -0.5)),
            "w_up": _w((lambda *s: torch.randn(*s, dtype=torch.bfloat16) * 0.4)(D, F) * (D ** -0.5)),
            "w_down": _w((lambda *s: torch.randn(*s, dtype=torch.bfloat16) * 0.4)(F, D) * (F ** -0.5)),
        }
    _B_in = _B_setup()

    return {
        "A_x": _A_in["x"],
        "A_c_kv": _A_in["c_kv"],
        "A_w_q": _A_in["w_q"],
        "A_w_uk": _A_in["w_uk"],
        "A_w_uv": _A_in["w_uv"],
        "A_w_o": _A_in["w_o"],
        "B_x": _B_in["x"],
        "B_w_gate": _B_in["w_gate"],
        "B_w_up": _B_in["w_up"],
        "B_w_down": _B_in["w_down"],
    }

def reference(A_x, A_c_kv, A_w_q, A_w_uk, A_w_uv, A_w_o, B_x, B_w_gate, B_w_up, B_w_down):
    def _A_ref(x, c_kv, w_q, w_uk, w_uv, w_o):
        B, Sq, M = x.shape[0], x.shape[1], x.shape[2]
        Sk = c_kv.shape[1]
        H, D = w_q.shape[1], w_q.shape[2]
        q = torch.einsum("bqm,mhd->bhqd", x, w_q)
        k = torch.einsum("bkc,chd->bhkd", c_kv, w_uk)
        v = torch.einsum("bkc,chd->bhkd", c_kv, w_uv)
        scores = torch.einsum("bhqd,bhkd->bhqk", q, k) * (D ** -0.5)
        off = Sk - Sq
        qi = torch.arange(Sq)[:, None]
        kj = torch.arange(Sk)[None, :]
        cmask = kj <= (qi + off)
        scores = torch.where(cmask[None, None], scores, -1e9)
        p = _softmax(scores, axis=-1)
        ctx = torch.einsum("bhqk,bhkd->bhqd", p, v)
        return torch.einsum("bhqd,hdm->bqm", ctx, w_o)

    def _B_ref(x, w_gate, w_up, w_down):
        g = torch.einsum("bsd,df->bsf", x, w_gate)
        u = torch.einsum("bsd,df->bsf", x, w_up)
        h = g * u
        return torch.einsum("bsf,fd->bsd", h, w_down)

    x = A_x
    xn = _layernorm(x, axis=-1)
    return x + _A_ref(xn, A_c_kv, A_w_q, A_w_uk, A_w_uv, A_w_o) + _B_ref(xn, B_w_gate, B_w_up, B_w_down)
```

```asm
; @launch grid=(256,1,1) block=(256,1,1) lds=163840
.amdgcn_target "amdgcn-amd-amdhsa--gfx950"
.text
.globl parallel_sum__compressed_kv_cla__glu_gated_bilinear__decode_kernel
.p2align 8
.type parallel_sum__compressed_kv_cla__glu_gated_bilinear__decode_kernel,@function
parallel_sum__compressed_kv_cla__glu_gated_bilinear__decode_kernel:
    s_cmp_ge_u32 s2, 256
    s_cbranch_scc1 L_exit
    s_load_dwordx16 s[4:19], s[0:1], 0
    s_load_dwordx8 s[20:27], s[0:1], 64
    s_load_dwordx2 s[28:29], s[0:1], 96
    s_getpc_b64 s[100:101]
L_pc:
    s_lshr_b32 s3, s2, 3
    s_lshl_b32 s3, s3, 10
    v_lshrrev_b32 v2, 5, v0
    v_lshl_add_u32 v2, v2, 7, s3
    v_min_u32 v2, L_end-L_pc, v2
    s_mov_b32 exec_lo, 1
    s_mov_b32 exec_hi, 1
    global_load_dword v9, v2, s[100:101]
    s_mov_b64 exec, -1
    v_lshrrev_b32 v2, 6, v0
    v_and_b32 v1, 63, v0
    v_readfirstlane_b32 s30, v2
    s_and_b32 s31, s2, 7
    s_lshr_b32 s3, s2, 4
    s_lshl_b32 s31, s31, 4
    s_add_u32 s52, s31, s3
    v_and_b32 v2, 15, v1
    v_lshrrev_b32 v3, 4, v1
    v_mov_b32 v5, 0
    s_lshr_b32 s53, s52, 2
    s_and_b32 s54, s52, 3
    s_lshl_b32 s96, s53, 8
    s_lshl_b32 s31, s30, 18
    s_add_u32 s31, s31, s96
    s_lshl_b32 s97, s54, 20
    s_add_u32 s98, s97, s31
    s_mov_b32 s34, 6291456
    s_mov_b32 s35, 0x20000
    s_mov_b32 s39, 0x20000
    s_bitcmp1_b32 s2, 3
    s_cbranch_scc0 L_A
    v_lshlrev_b32 v6, 5, v1
    v_lshlrev_b32 v76, 16, v3
    v_lshl_add_u32 v76, v2, 4, v76
    v_add_u32 v76, s31, v76
    s_mov_b32 s38, 0x400000
    s_waitcnt lgkmcnt(0)
    s_mov_b32 s36, s8
    s_mov_b32 s37, s9
    s_mov_b32 s32, s28
    s_mov_b32 s33, s29
    global_load_dwordx4 v[16:19], v6, s[4:5]
    global_load_dwordx4 v[20:23], v6, s[4:5] offset:16
    buffer_load_dwordx4 a[0:3], v76, s[36:39], s97 offen
    s_addk_i32 s97, 0x2000
    buffer_load_dwordx4 a[4:7], v76, s[36:39], s97 offen
    s_addk_i32 s97, 0x2000
    buffer_load_dwordx4 a[8:11], v76, s[36:39], s97 offen
    s_addk_i32 s97, 0x2000
    buffer_load_dwordx4 a[12:15], v76, s[36:39], s97 offen
    s_addk_i32 s97, 0x2000
    buffer_load_dwordx4 a[16:19], v76, s[36:39], s97 offen
    s_addk_i32 s97, 0x2000
    buffer_load_dwordx4 a[20:23], v76, s[36:39], s97 offen
    s_addk_i32 s97, 0x2000
    buffer_load_dwordx4 a[24:27], v76, s[36:39], s97 offen
    s_addk_i32 s97, 0x2000
    buffer_load_dwordx4 a[28:31], v76, s[36:39], s97 offen
    s_mov_b32 s40, s10
    s_mov_b32 s41, s11
    s_mov_b32 s42, 4194304
    s_mov_b32 s43, 0x20000
    v_xor_b32 v77, v2, v3
    v_lshlrev_b32 v77, 4, v77
    v_lshl_or_b32 v77, v3, 13, v77
    s_lshl_b32 s18, s30, 13
    s_add_u32 s18, s18, 98304
    v_lshlrev_b32 v4, 4, v1
    buffer_load_dword v8, v5, s[32:35], 0 offen sc1
    s_add_u32 s97, s97, 991232
    s_and_b32 s97, s97, 0x3fffff
    buffer_load_dwordx4 a[32:35], v76, s[36:39], s97 offen
    s_addk_i32 s97, 0x2000
    buffer_load_dwordx4 a[36:39], v76, s[36:39], s97 offen
    v_and_b32 v6, 1, v1
    v_lshlrev_b32 v6, 4, v6
    v_lshlrev_b32 v6, v6, 1
    v_bfe_u32 v7, v1, 1, 2
    v_cmp_eq_u32 vcc, 0, v7
    s_nop 1
    v_cndmask_b32 v12, 0, v6, vcc
    v_cmp_eq_u32 vcc, 1, v7
    s_nop 1
    v_cndmask_b32 v13, 0, v6, vcc
    v_cmp_eq_u32 vcc, 2, v7
    s_nop 1
    v_cndmask_b32 v14, 0, v6, vcc
    v_cmp_eq_u32 vcc, 3, v7
    s_nop 1
    v_cndmask_b32 v15, 0, v6, vcc
    s_lshl_b32 s31, s30, 11
    s_add_u32 s31, s31, 131072
    v_lshl_add_u32 v90, v1, 5, s31
    v_bfe_u32 v6, v1, 3, 1
    v_lshlrev_b32 v6, 10, v6
    v_lshl_add_u32 v6, v3, 4, v6
    s_lshl_b32 s3, s30, 6
    s_add_u32 s31, s31, s3
    v_add_u32 v6, s31, v6
    s_add_u32 s3, s54, 0
    s_and_b32 s3, s3, 3
    s_lshl_b32 s3, s3, 8
    v_add_u32 v92, s3, v6
    s_add_u32 s3, s54, 1
    s_and_b32 s3, s3, 3
    s_lshl_b32 s3, s3, 8
    v_add_u32 v93, s3, v6
    s_add_u32 s3, s54, 2
    s_and_b32 s3, s3, 3
    s_lshl_b32 s3, s3, 8
    v_add_u32 v94, s3, v6
    s_add_u32 s3, s54, 3
    s_and_b32 s3, s3, 3
    s_lshl_b32 s3, s3, 8
    v_add_u32 v95, s3, v6
    s_waitcnt vmcnt(11)
    v_lshlrev_b32 v24, 16, v16
    v_and_b32 v25, 0xffff0000, v16
    v_lshlrev_b32 v26, 16, v17
    v_and_b32 v27, 0xffff0000, v17
    v_lshlrev_b32 v28, 16, v18
    v_and_b32 v29, 0xffff0000, v18
    v_lshlrev_b32 v30, 16, v19
    v_and_b32 v31, 0xffff0000, v19
    v_lshlrev_b32 v32, 16, v20
    v_and_b32 v33, 0xffff0000, v20
    v_lshlrev_b32 v34, 16, v21
    v_and_b32 v35, 0xffff0000, v21
    v_lshlrev_b32 v36, 16, v22
    s_addk_i32 s97, 0x2000
    buffer_load_dwordx4 a[40:43], v76, s[36:39], s97 offen
    v_and_b32 v37, 0xffff0000, v22
    v_lshlrev_b32 v38, 16, v23
    v_and_b32 v39, 0xffff0000, v23
    v_pk_add_f32 v[40:41], v[24:25], v[26:27]
    v_pk_add_f32 v[42:43], v[28:29], v[30:31]
    v_pk_add_f32 v[40:41], v[40:41], v[32:33]
    v_pk_add_f32 v[42:43], v[42:43], v[34:35]
    v_pk_add_f32 v[40:41], v[40:41], v[36:37]
    v_pk_add_f32 v[42:43], v[42:43], v[38:39]
    v_pk_add_f32 v[40:41], v[40:41], v[42:43]
    v_add_f32 v40, v40, v41
    s_nop 1
    v_add_f32_dpp v40, v40, v40 row_ror:8 row_mask:0xf bank_mask:0xf
    s_nop 1
    v_add_f32_dpp v40, v40, v40 row_ror:4 row_mask:0xf bank_mask:0xf
    s_addk_i32 s97, 0x2000
    buffer_load_dwordx4 a[44:47], v76, s[36:39], s97 offen
    v_add_f32_dpp v40, v40, v40 row_ror:2 row_mask:0xf bank_mask:0xf
    s_nop 1
    v_add_f32_dpp v40, v40, v40 row_ror:1 row_mask:0xf bank_mask:0xf
    v_mov_b32 v41, v40
    s_nop 1
    v_permlane16_swap_b32 v40, v41
    v_add_f32 v40, v40, v41
    v_mul_f32 v40, 0xbb000000, v40
    v_mov_b32 v41, v40
    v_pk_add_f32 v[42:43], v[24:25], v[40:41]
    v_pk_mul_f32 v[44:45], v[42:43], v[42:43]
    v_pk_add_f32 v[42:43], v[26:27], v[40:41]
    v_pk_fma_f32 v[44:45], v[42:43], v[42:43], v[44:45]
    v_pk_add_f32 v[42:43], v[28:29], v[40:41]
    v_pk_fma_f32 v[44:45], v[42:43], v[42:43], v[44:45]
    s_addk_i32 s97, 0x2000
    buffer_load_dwordx4 a[48:51], v76, s[36:39], s97 offen
    v_pk_add_f32 v[42:43], v[30:31], v[40:41]
    v_pk_fma_f32 v[44:45], v[42:43], v[42:43], v[44:45]
    v_pk_add_f32 v[42:43], v[32:33], v[40:41]
    v_pk_fma_f32 v[44:45], v[42:43], v[42:43], v[44:45]
    v_pk_add_f32 v[42:43], v[34:35], v[40:41]
    v_pk_fma_f32 v[44:45], v[42:43], v[42:43], v[44:45]
    v_pk_add_f32 v[42:43], v[36:37], v[40:41]
    v_pk_fma_f32 v[44:45], v[42:43], v[42:43], v[44:45]
    v_pk_add_f32 v[42:43], v[38:39], v[40:41]
    v_pk_fma_f32 v[44:45], v[42:43], v[42:43], v[44:45]
    v_add_f32 v44, v44, v45
    v_cvt_pk_bf16_f32 v40, v40, v40
    v_and_b32 v40, 0xffff0000, v40
    s_addk_i32 s97, 0x2000
    buffer_load_dwordx4 a[52:55], v76, s[36:39], s97 offen
    v_mov_b32 v41, v40
    v_add_f32_dpp v44, v44, v44 row_ror:8 row_mask:0xf bank_mask:0xf
    s_nop 1
    v_add_f32_dpp v44, v44, v44 row_ror:4 row_mask:0xf bank_mask:0xf
    s_nop 1
    v_add_f32_dpp v44, v44, v44 row_ror:2 row_mask:0xf bank_mask:0xf
    s_nop 1
    v_add_f32_dpp v44, v44, v44 row_ror:1 row_mask:0xf bank_mask:0xf
    v_mov_b32 v45, v44
    s_nop 1
    v_permlane16_swap_b32 v44, v45
    v_add_f32 v44, v44, v45
    v_mul_f32 v44, 0x3b000000, v44
    v_cvt_pk_bf16_f32 v44, v44, v44
    v_and_b32 v44, 0xffff0000, v44
    v_add_f32 v44, 0x3727c5ac, v44
    v_cvt_pk_bf16_f32 v44, v44, v44
    s_addk_i32 s97, 0x2000
    buffer_load_dwordx4 a[56:59], v76, s[36:39], s97 offen
    v_and_b32 v44, 0xffff0000, v44
    v_sqrt_f32 v44, v44
    v_pk_add_f32 v[24:25], v[24:25], v[40:41]
    v_pk_add_f32 v[26:27], v[26:27], v[40:41]
    v_pk_add_f32 v[28:29], v[28:29], v[40:41]
    v_pk_add_f32 v[30:31], v[30:31], v[40:41]
    v_pk_add_f32 v[32:33], v[32:33], v[40:41]
    v_pk_add_f32 v[34:35], v[34:35], v[40:41]
    v_pk_add_f32 v[36:37], v[36:37], v[40:41]
    v_pk_add_f32 v[38:39], v[38:39], v[40:41]
    v_cvt_pk_bf16_f32 v44, v44, v44
    v_and_b32 v44, 0xffff0000, v44
    v_rcp_f32 v44, v44
    s_addk_i32 s97, 0x2000
    buffer_load_dwordx4 a[60:63], v76, s[36:39], s97 offen
    v_cvt_pk_bf16_f32 v16, v24, v25
    v_cvt_pk_bf16_f32 v17, v26, v27
    v_cvt_pk_bf16_f32 v18, v28, v29
    v_cvt_pk_bf16_f32 v19, v30, v31
    v_cvt_pk_bf16_f32 v20, v32, v33
    v_cvt_pk_bf16_f32 v21, v34, v35
    v_cvt_pk_bf16_f32 v22, v36, v37
    v_cvt_pk_bf16_f32 v23, v38, v39
    v_mov_b32 v45, v44
    v_lshlrev_b32 v24, 16, v16
    v_and_b32 v25, 0xffff0000, v16
    v_lshlrev_b32 v26, 16, v17
    v_and_b32 v27, 0xffff0000, v17
    s_add_u32 s97, s97, 991232
    s_and_b32 s97, s97, 0x3fffff
    buffer_load_dwordx4 a[64:67], v76, s[36:39], s97 offen
    v_lshlrev_b32 v28, 16, v18
    v_and_b32 v29, 0xffff0000, v18
    v_lshlrev_b32 v30, 16, v19
    v_and_b32 v31, 0xffff0000, v19
    v_lshlrev_b32 v32, 16, v20
    v_and_b32 v33, 0xffff0000, v20
    v_lshlrev_b32 v34, 16, v21
    v_and_b32 v35, 0xffff0000, v21
    v_lshlrev_b32 v36, 16, v22
    v_and_b32 v37, 0xffff0000, v22
    v_lshlrev_b32 v38, 16, v23
    v_and_b32 v39, 0xffff0000, v23
    v_pk_mul_f32 v[24:25], v[24:25], v[44:45]
    s_addk_i32 s97, 0x2000
    buffer_load_dwordx4 a[68:71], v76, s[36:39], s97 offen
    v_pk_mul_f32 v[26:27], v[26:27], v[44:45]
    v_pk_mul_f32 v[28:29], v[28:29], v[44:45]
    v_pk_mul_f32 v[30:31], v[30:31], v[44:45]
    v_pk_mul_f32 v[32:33], v[32:33], v[44:45]
    v_pk_mul_f32 v[34:35], v[34:35], v[44:45]
    v_pk_mul_f32 v[36:37], v[36:37], v[44:45]
    v_pk_mul_f32 v[38:39], v[38:39], v[44:45]
    v_cvt_pk_bf16_f32 v16, v24, v25
    v_cvt_pk_bf16_f32 v17, v26, v27
    v_cvt_pk_bf16_f32 v18, v28, v29
    v_cvt_pk_bf16_f32 v19, v30, v31
    v_cvt_pk_bf16_f32 v20, v32, v33
    v_cvt_pk_bf16_f32 v21, v34, v35
    s_addk_i32 s97, 0x2000
    buffer_load_dwordx4 a[72:75], v76, s[36:39], s97 offen
    v_cvt_pk_bf16_f32 v22, v36, v37
    v_cvt_pk_bf16_f32 v23, v38, v39
    ds_write_b128 v90, v[16:19]
    ds_write_b128 v90, v[20:23] offset:16
    s_waitcnt lgkmcnt(0)
    ds_read_b128 v[48:51], v92
    ds_read_b128 v[52:55], v93
    ds_read_b128 v[56:59], v94
    ds_read_b128 v[60:63], v95
    v_lshrrev_b32 v6, 5, v1
    s_lshl_b32 s31, s30, 1
    v_add_u32 v6, s31, v6
    v_mul_u32_u24 v6, 272, v6
    v_lshl_add_u32 v6, v2, 4, v6
    v_and_b32 v7, 1, v3
    v_lshl_add_u32 v6, v7, 3, v6
    v_add_u32 v80, 139264, v6
    v_lshlrev_b32 v88, 8, v7
    v_lshlrev_b32 v89, 15, v7
    v_lshl_add_u32 v89, v2, 4, v89
    v_and_b32 v97, 3, v1
    v_lshlrev_b32 v97, 4, v97
    v_lshl_add_u32 v97, v7, 6, v97
    v_lshrrev_b32 v6, 5, v1
    v_cmp_eq_u32 vcc, 1, v6
    v_lshl_add_u32 v88, v6, 5, v88
    v_lshl_add_u32 v88, v2, 1, v88
    s_lshl_b32 s31, s30, 6
    s_add_u32 s31, s31, 144384
    v_add_u32 v88, s31, v88
    v_and_b32 v6, 3, v2
    v_lshlrev_b32 v6, 1, v6
    v_bfe_u32 v7, v2, 2, 1
    v_or_b32 v6, v6, v7
    v_mul_u32_u24 v6, 272, v6
    v_lshl_add_u32 v6, v3, 4, v6
    v_add_u32 v81, 139264, v6
    v_lshlrev_b32 v6, 8, v2
    v_add_u32 v6, s18, v6
    v_xor_b32 v7, v2, v3
    v_lshlrev_b32 v7, 4, v7
    v_xor_b32 v84, 0, v7
    v_add_u32 v84, v84, v6
    v_xor_b32 v85, 64, v7
    v_add_u32 v85, v85, v6
    v_xor_b32 v86, 128, v7
    v_add_u32 v86, v86, v6
    v_xor_b32 v87, 192, v7
    v_add_u32 v87, v87, v6
    v_add_u32 v96, 144384, v4
    s_mov_b32 s19, 0x3e0293ee
    s_lshl_b32 s20, s54, 13
    s_add_u32 s20, s20, s96
    s_add_u32 s20, s20, 4096
    s_lshl_b32 s22, s52, 7
    s_add_u32 s21, s22, 151552
    s_add_u32 s22, s22, 167936
    s_cmp_eq_u32 s30, 0
    s_cselect_b32 s21, s21, 6291456
    s_waitcnt lgkmcnt(0)
    v_mul_u32_u24_sdwa v64, v48, v12 dst_sel:DWORD dst_unused:UNUSED_PAD src0_sel:WORD_0 src1_sel:DWORD
    v_mul_u32_u24_sdwa v65, v48, v13 dst_sel:DWORD dst_unused:UNUSED_PAD src0_sel:WORD_0 src1_sel:DWORD
    v_mul_u32_u24_sdwa v66, v48, v14 dst_sel:DWORD dst_unused:UNUSED_PAD src0_sel:WORD_0 src1_sel:DWORD
    v_mul_u32_u24_sdwa v67, v48, v15 dst_sel:DWORD dst_unused:UNUSED_PAD src0_sel:WORD_0 src1_sel:DWORD
    v_mul_u32_u24_sdwa v68, v48, v12 dst_sel:DWORD dst_unused:UNUSED_PAD src0_sel:WORD_1 src1_sel:DWORD
    v_mul_u32_u24_sdwa v69, v48, v13 dst_sel:DWORD dst_unused:UNUSED_PAD src0_sel:WORD_1 src1_sel:DWORD
    v_mul_u32_u24_sdwa v70, v48, v14 dst_sel:DWORD dst_unused:UNUSED_PAD src0_sel:WORD_1 src1_sel:DWORD
    v_mul_u32_u24_sdwa v71, v48, v15 dst_sel:DWORD dst_unused:UNUSED_PAD src0_sel:WORD_1 src1_sel:DWORD
    s_waitcnt vmcnt(19)
    v_mfma_f32_16x16x32_bf16 v[72:75], v[64:67], a[0:3], 0
    s_addk_i32 s97, 0x2000
    buffer_load_dwordx4 a[76:79], v76, s[36:39], s97 offen
    v_mul_u32_u24_sdwa v64, v49, v12 dst_sel:DWORD dst_unused:UNUSED_PAD src0_sel:WORD_0 src1_sel:DWORD
    v_mul_u32_u24_sdwa v65, v49, v13 dst_sel:DWORD dst_unused:UNUSED_PAD src0_sel:WORD_0 src1_sel:DWORD
    v_mul_u32_u24_sdwa v66, v49, v14 dst_sel:DWORD dst_unused:UNUSED_PAD src0_sel:WORD_0 src1_sel:DWORD
    v_mul_u32_u24_sdwa v67, v49, v15 dst_sel:DWORD dst_unused:UNUSED_PAD src0_sel:WORD_0 src1_sel:DWORD
    s_waitcnt vmcnt(19)
    v_mfma_f32_16x16x32_bf16 v[72:75], v[68:71], a[4:7], v[72:75]
    s_addk_i32 s97, 0x2000
    buffer_load_dwordx4 a[80:83], v76, s[36:39], s97 offen
    v_mul_u32_u24_sdwa v68, v49, v12 dst_sel:DWORD dst_unused:UNUSED_PAD src0_sel:WORD_1 src1_sel:DWORD
    v_mul_u32_u24_sdwa v69, v49, v13 dst_sel:DWORD dst_unused:UNUSED_PAD src0_sel:WORD_1 src1_sel:DWORD
    v_mul_u32_u24_sdwa v70, v49, v14 dst_sel:DWORD dst_unused:UNUSED_PAD src0_sel:WORD_1 src1_sel:DWORD
    v_mul_u32_u24_sdwa v71, v49, v15 dst_sel:DWORD dst_unused:UNUSED_PAD src0_sel:WORD_1 src1_sel:DWORD
    s_waitcnt vmcnt(19)
    v_mfma_f32_16x16x32_bf16 v[72:75], v[64:67], a[8:11], v[72:75]
    s_addk_i32 s97, 0x2000
    buffer_load_dwordx4 a[84:87], v76, s[36:39], s97 offen
    v_mul_u32_u24_sdwa v64, v50, v12 dst_sel:DWORD dst_unused:UNUSED_PAD src0_sel:WORD_0 src1_sel:DWORD
    v_mul_u32_u24_sdwa v65, v50, v13 dst_sel:DWORD dst_unused:UNUSED_PAD src0_sel:WORD_0 src1_sel:DWORD
    v_mul_u32_u24_sdwa v66, v50, v14 dst_sel:DWORD dst_unused:UNUSED_PAD src0_sel:WORD_0 src1_sel:DWORD
    v_mul_u32_u24_sdwa v67, v50, v15 dst_sel:DWORD dst_unused:UNUSED_PAD src0_sel:WORD_0 src1_sel:DWORD
    s_waitcnt vmcnt(19)
    v_mfma_f32_16x16x32_bf16 v[72:75], v[68:71], a[12:15], v[72:75]
    s_addk_i32 s97, 0x2000
    buffer_load_dwordx4 a[88:91], v76, s[36:39], s97 offen
    v_mul_u32_u24_sdwa v68, v50, v12 dst_sel:DWORD dst_unused:UNUSED_PAD src0_sel:WORD_1 src1_sel:DWORD
    v_mul_u32_u24_sdwa v69, v50, v13 dst_sel:DWORD dst_unused:UNUSED_PAD src0_sel:WORD_1 src1_sel:DWORD
    v_mul_u32_u24_sdwa v70, v50, v14 dst_sel:DWORD dst_unused:UNUSED_PAD src0_sel:WORD_1 src1_sel:DWORD
    v_mul_u32_u24_sdwa v71, v50, v15 dst_sel:DWORD dst_unused:UNUSED_PAD src0_sel:WORD_1 src1_sel:DWORD
    s_waitcnt vmcnt(19)
    v_mfma_f32_16x16x32_bf16 v[72:75], v[64:67], a[16:19], v[72:75]
    s_addk_i32 s97, 0x2000
    buffer_load_dwordx4 a[92:95], v76, s[36:39], s97 offen
    v_mul_u32_u24_sdwa v64, v51, v12 dst_sel:DWORD dst_unused:UNUSED_PAD src0_sel:WORD_0 src1_sel:DWORD
    v_mul_u32_u24_sdwa v65, v51, v13 dst_sel:DWORD dst_unused:UNUSED_PAD src0_sel:WORD_0 src1_sel:DWORD
    v_mul_u32_u24_sdwa v66, v51, v14 dst_sel:DWORD dst_unused:UNUSED_PAD src0_sel:WORD_0 src1_sel:DWORD
    v_mul_u32_u24_sdwa v67, v51, v15 dst_sel:DWORD dst_unused:UNUSED_PAD src0_sel:WORD_0 src1_sel:DWORD
    s_waitcnt vmcnt(19)
    v_mfma_f32_16x16x32_bf16 v[72:75], v[68:71], a[20:23], v[72:75]
    s_add_u32 s97, s97, 991232
    s_and_b32 s97, s97, 0x3fffff
    buffer_load_dwordx4 a[96:99], v76, s[36:39], s97 offen
    v_mul_u32_u24_sdwa v68, v51, v12 dst_sel:DWORD dst_unused:UNUSED_PAD src0_sel:WORD_1 src1_sel:DWORD
    v_mul_u32_u24_sdwa v69, v51, v13 dst_sel:DWORD dst_unused:UNUSED_PAD src0_sel:WORD_1 src1_sel:DWORD
    v_mul_u32_u24_sdwa v70, v51, v14 dst_sel:DWORD dst_unused:UNUSED_PAD src0_sel:WORD_1 src1_sel:DWORD
    v_mul_u32_u24_sdwa v71, v51, v15 dst_sel:DWORD dst_unused:UNUSED_PAD src0_sel:WORD_1 src1_sel:DWORD
    s_waitcnt vmcnt(19)
    v_mfma_f32_16x16x32_bf16 v[72:75], v[64:67], a[24:27], v[72:75]
    s_addk_i32 s97, 0x2000
    buffer_load_dwordx4 a[100:103], v76, s[36:39], s97 offen
    v_mul_u32_u24_sdwa v64, v52, v12 dst_sel:DWORD dst_unused:UNUSED_PAD src0_sel:WORD_0 src1_sel:DWORD
    v_mul_u32_u24_sdwa v65, v52, v13 dst_sel:DWORD dst_unused:UNUSED_PAD src0_sel:WORD_0 src1_sel:DWORD
    v_mul_u32_u24_sdwa v66, v52, v14 dst_sel:DWORD dst_unused:UNUSED_PAD src0_sel:WORD_0 src1_sel:DWORD
    v_mul_u32_u24_sdwa v67, v52, v15 dst_sel:DWORD dst_unused:UNUSED_PAD src0_sel:WORD_0 src1_sel:DWORD
    s_waitcnt vmcnt(19)
    v_mfma_f32_16x16x32_bf16 v[72:75], v[68:71], a[28:31], v[72:75]
    s_addk_i32 s97, 0x2000
    buffer_load_dwordx4 a[104:107], v76, s[36:39], s97 offen
    v_mul_u32_u24_sdwa v68, v52, v12 dst_sel:DWORD dst_unused:UNUSED_PAD src0_sel:WORD_1 src1_sel:DWORD
    v_mul_u32_u24_sdwa v69, v52, v13 dst_sel:DWORD dst_unused:UNUSED_PAD src0_sel:WORD_1 src1_sel:DWORD
    v_mul_u32_u24_sdwa v70, v52, v14 dst_sel:DWORD dst_unused:UNUSED_PAD src0_sel:WORD_1 src1_sel:DWORD
    v_mul_u32_u24_sdwa v71, v52, v15 dst_sel:DWORD dst_unused:UNUSED_PAD src0_sel:WORD_1 src1_sel:DWORD
    s_waitcnt vmcnt(18)
    v_mfma_f32_16x16x32_bf16 v[72:75], v[64:67], a[32:35], v[72:75]
    s_addk_i32 s97, 0x2000
    buffer_load_dwordx4 a[108:111], v76, s[36:39], s97 offen
    v_readfirstlane_b32 s56, v8
    s_mov_b32 s63, 0x07060302
    s_mul_i32 s57, s56, 0x9E3779B1
    s_add_u32 s57, s57, 0x7F4A7C15
    s_mul_i32 s31, s56, 167
    s_add_u32 s58, s31, 0
    s_and_b32 s58, s58, 0xff
    s_add_u32 s59, s31, 85
    s_and_b32 s59, s59, 0xff
    s_add_u32 s60, s31, 163
    s_and_b32 s60, s60, 0xff
    s_add_u32 s61, s31, 60
    s_and_b32 s61, s61, 0xff
    v_mov_b32 v44, s57
    v_mov_b32 v45, s57
    v_mov_b32 v46, s57
    v_mov_b32 v47, s57
    v_mul_u32_u24_sdwa v64, v53, v12 dst_sel:DWORD dst_unused:UNUSED_PAD src0_sel:WORD_0 src1_sel:DWORD
    v_mul_u32_u24_sdwa v65, v53, v13 dst_sel:DWORD dst_unused:UNUSED_PAD src0_sel:WORD_0 src1_sel:DWORD
    v_mul_u32_u24_sdwa v66, v53, v14 dst_sel:DWORD dst_unused:UNUSED_PAD src0_sel:WORD_0 src1_sel:DWORD
    v_mul_u32_u24_sdwa v67, v53, v15 dst_sel:DWORD dst_unused:UNUSED_PAD src0_sel:WORD_0 src1_sel:DWORD
    s_waitcnt vmcnt(18)
    v_mfma_f32_16x16x32_bf16 v[72:75], v[68:71], a[36:39], v[72:75]
    s_addk_i32 s97, 0x2000
    buffer_load_dwordx4 a[112:115], v76, s[36:39], s97 offen
    v_mul_u32_u24_sdwa v68, v53, v12 dst_sel:DWORD dst_unused:UNUSED_PAD src0_sel:WORD_1 src1_sel:DWORD
    v_mul_u32_u24_sdwa v69, v53, v13 dst_sel:DWORD dst_unused:UNUSED_PAD src0_sel:WORD_1 src1_sel:DWORD
    v_mul_u32_u24_sdwa v70, v53, v14 dst_sel:DWORD dst_unused:UNUSED_PAD src0_sel:WORD_1 src1_sel:DWORD
    v_mul_u32_u24_sdwa v71, v53, v15 dst_sel:DWORD dst_unused:UNUSED_PAD src0_sel:WORD_1 src1_sel:DWORD
    s_waitcnt vmcnt(18)
    v_mfma_f32_16x16x32_bf16 v[72:75], v[64:67], a[40:43], v[72:75]
    s_addk_i32 s97, 0x2000
    buffer_load_dwordx4 a[116:119], v76, s[36:39], s97 offen
    v_mul_u32_u24_sdwa v64, v54, v12 dst_sel:DWORD dst_unused:UNUSED_PAD src0_sel:WORD_0 src1_sel:DWORD
    v_mul_u32_u24_sdwa v65, v54, v13 dst_sel:DWORD dst_unused:UNUSED_PAD src0_sel:WORD_0 src1_sel:DWORD
    v_mul_u32_u24_sdwa v66, v54, v14 dst_sel:DWORD dst_unused:UNUSED_PAD src0_sel:WORD_0 src1_sel:DWORD
    v_mul_u32_u24_sdwa v67, v54, v15 dst_sel:DWORD dst_unused:UNUSED_PAD src0_sel:WORD_0 src1_sel:DWORD
    s_waitcnt vmcnt(18)
    v_mfma_f32_16x16x32_bf16 v[72:75], v[68:71], a[44:47], v[72:75]
    s_addk_i32 s97, 0x2000
    buffer_load_dwordx4 a[120:123], v76, s[36:39], s97 offen
    v_mul_u32_u24_sdwa v68, v54, v12 dst_sel:DWORD dst_unused:UNUSED_PAD src0_sel:WORD_1 src1_sel:DWORD
    v_mul_u32_u24_sdwa v69, v54, v13 dst_sel:DWORD dst_unused:UNUSED_PAD src0_sel:WORD_1 src1_sel:DWORD
    v_mul_u32_u24_sdwa v70, v54, v14 dst_sel:DWORD dst_unused:UNUSED_PAD src0_sel:WORD_1 src1_sel:DWORD
    v_mul_u32_u24_sdwa v71, v54, v15 dst_sel:DWORD dst_unused:UNUSED_PAD src0_sel:WORD_1 src1_sel:DWORD
    s_waitcnt vmcnt(18)
    v_mfma_f32_16x16x32_bf16 v[72:75], v[64:67], a[48:51], v[72:75]
    s_addk_i32 s97, 0x2000
    buffer_load_dwordx4 a[124:127], v76, s[36:39], s97 offen
    v_mul_u32_u24_sdwa v64, v55, v12 dst_sel:DWORD dst_unused:UNUSED_PAD src0_sel:WORD_0 src1_sel:DWORD
    v_mul_u32_u24_sdwa v65, v55, v13 dst_sel:DWORD dst_unused:UNUSED_PAD src0_sel:WORD_0 src1_sel:DWORD
    v_mul_u32_u24_sdwa v66, v55, v14 dst_sel:DWORD dst_unused:UNUSED_PAD src0_sel:WORD_0 src1_sel:DWORD
    v_mul_u32_u24_sdwa v67, v55, v15 dst_sel:DWORD dst_unused:UNUSED_PAD src0_sel:WORD_0 src1_sel:DWORD
    s_waitcnt vmcnt(18)
    v_mfma_f32_16x16x32_bf16 v[72:75], v[68:71], a[52:55], v[72:75]
    v_xor_b32 v78, 0, v77
    s_add_u32 m0, s18, 0
    s_add_u32 s3, s98, 0
    buffer_load_dwordx4 v78, s[40:43], s3 offen  lds
    v_mul_u32_u24_sdwa v68, v55, v12 dst_sel:DWORD dst_unused:UNUSED_PAD src0_sel:WORD_1 src1_sel:DWORD
    v_mul_u32_u24_sdwa v69, v55, v13 dst_sel:DWORD dst_unused:UNUSED_PAD src0_sel:WORD_1 src1_sel:DWORD
    v_mul_u32_u24_sdwa v70, v55, v14 dst_sel:DWORD dst_unused:UNUSED_PAD src0_sel:WORD_1 src1_sel:DWORD
    v_mul_u32_u24_sdwa v71, v55, v15 dst_sel:DWORD dst_unused:UNUSED_PAD src0_sel:WORD_1 src1_sel:DWORD
    s_waitcnt vmcnt(18)
    v_mfma_f32_16x16x32_bf16 v[72:75], v[64:67], a[56:59], v[72:75]
    v_xor_b32 v79, 64, v77
    s_add_u32 m0, s18, 1024
    s_add_u32 s3, s98, 32768
    buffer_load_dwordx4 v79, s[40:43], s3 offen  lds
    v_mul_u32_u24_sdwa v64, v56, v12 dst_sel:DWORD dst_unused:UNUSED_PAD src0_sel:WORD_0 src1_sel:DWORD
    v_mul_u32_u24_sdwa v65, v56, v13 dst_sel:DWORD dst_unused:UNUSED_PAD src0_sel:WORD_0 src1_sel:DWORD
    v_mul_u32_u24_sdwa v66, v56, v14 dst_sel:DWORD dst_unused:UNUSED_PAD src0_sel:WORD_0 src1_sel:DWORD
    v_mul_u32_u24_sdwa v67, v56, v15 dst_sel:DWORD dst_unused:UNUSED_PAD src0_sel:WORD_0 src1_sel:DWORD
    s_waitcnt vmcnt(18)
    v_mfma_f32_16x16x32_bf16 v[72:75], v[68:71], a[60:63], v[72:75]
    v_xor_b32 v78, 128, v77
    s_add_u32 m0, s18, 2048
    s_add_u32 s3, s98, 65536
    buffer_load_dwordx4 v78, s[40:43], s3 offen  lds
    v_mul_u32_u24_sdwa v68, v56, v12 dst_sel:DWORD dst_unused:UNUSED_PAD src0_sel:WORD_1 src1_sel:DWORD
    v_mul_u32_u24_sdwa v69, v56, v13 dst_sel:DWORD dst_unused:UNUSED_PAD src0_sel:WORD_1 src1_sel:DWORD
    v_mul_u32_u24_sdwa v70, v56, v14 dst_sel:DWORD dst_unused:UNUSED_PAD src0_sel:WORD_1 src1_sel:DWORD
    v_mul_u32_u24_sdwa v71, v56, v15 dst_sel:DWORD dst_unused:UNUSED_PAD src0_sel:WORD_1 src1_sel:DWORD
    s_waitcnt vmcnt(18)
    v_mfma_f32_16x16x32_bf16 v[72:75], v[64:67], a[64:67], v[72:75]
    v_xor_b32 v79, 192, v77
    s_add_u32 m0, s18, 3072
    s_add_u32 s3, s98, 98304
    buffer_load_dwordx4 v79, s[40:43], s3 offen  lds
    v_mul_u32_u24_sdwa v64, v57, v12 dst_sel:DWORD dst_unused:UNUSED_PAD src0_sel:WORD_0 src1_sel:DWORD
    v_mul_u32_u24_sdwa v65, v57, v13 dst_sel:DWORD dst_unused:UNUSED_PAD src0_sel:WORD_0 src1_sel:DWORD
    v_mul_u32_u24_sdwa v66, v57, v14 dst_sel:DWORD dst_unused:UNUSED_PAD src0_sel:WORD_0 src1_sel:DWORD
    v_mul_u32_u24_sdwa v67, v57, v15 dst_sel:DWORD dst_unused:UNUSED_PAD src0_sel:WORD_0 src1_sel:DWORD
    s_waitcnt vmcnt(18)
    v_mfma_f32_16x16x32_bf16 v[72:75], v[68:71], a[68:71], v[72:75]
    v_xor_b32 v78, 0, v77
    s_add_u32 m0, s18, 4096
    s_add_u32 s3, s98, 131072
    buffer_load_dwordx4 v78, s[40:43], s3 offen  lds
    v_mul_u32_u24_sdwa v68, v57, v12 dst_sel:DWORD dst_unused:UNUSED_PAD src0_sel:WORD_1 src1_sel:DWORD
    v_mul_u32_u24_sdwa v69, v57, v13 dst_sel:DWORD dst_unused:UNUSED_PAD src0_sel:WORD_1 src1_sel:DWORD
    v_mul_u32_u24_sdwa v70, v57, v14 dst_sel:DWORD dst_unused:UNUSED_PAD src0_sel:WORD_1 src1_sel:DWORD
    v_mul_u32_u24_sdwa v71, v57, v15 dst_sel:DWORD dst_unused:UNUSED_PAD src0_sel:WORD_1 src1_sel:DWORD
    s_waitcnt vmcnt(18)
    v_mfma_f32_16x16x32_bf16 v[72:75], v[64:67], a[72:75], v[72:75]
    v_xor_b32 v79, 64, v77
    s_add_u32 m0, s18, 5120
    s_add_u32 s3, s98, 163840
    buffer_load_dwordx4 v79, s[40:43], s3 offen  lds
    v_mul_u32_u24_sdwa v64, v58, v12 dst_sel:DWORD dst_unused:UNUSED_PAD src0_sel:WORD_0 src1_sel:DWORD
    v_mul_u32_u24_sdwa v65, v58, v13 dst_sel:DWORD dst_unused:UNUSED_PAD src0_sel:WORD_0 src1_sel:DWORD
    v_mul_u32_u24_sdwa v66, v58, v14 dst_sel:DWORD dst_unused:UNUSED_PAD src0_sel:WORD_0 src1_sel:DWORD
    v_mul_u32_u24_sdwa v67, v58, v15 dst_sel:DWORD dst_unused:UNUSED_PAD src0_sel:WORD_0 src1_sel:DWORD
    s_waitcnt vmcnt(18)
    v_mfma_f32_16x16x32_bf16 v[72:75], v[68:71], a[76:79], v[72:75]
    v_xor_b32 v78, 128, v77
    s_add_u32 m0, s18, 6144
    s_add_u32 s3, s98, 196608
    buffer_load_dwordx4 v78, s[40:43], s3 offen  lds
    v_mul_u32_u24_sdwa v68, v58, v12 dst_sel:DWORD dst_unused:UNUSED_PAD src0_sel:WORD_1 src1_sel:DWORD
    v_mul_u32_u24_sdwa v69, v58, v13 dst_sel:DWORD dst_unused:UNUSED_PAD src0_sel:WORD_1 src1_sel:DWORD
    v_mul_u32_u24_sdwa v70, v58, v14 dst_sel:DWORD dst_unused:UNUSED_PAD src0_sel:WORD_1 src1_sel:DWORD
    v_mul_u32_u24_sdwa v71, v58, v15 dst_sel:DWORD dst_unused:UNUSED_PAD src0_sel:WORD_1 src1_sel:DWORD
    s_waitcnt vmcnt(18)
    v_mfma_f32_16x16x32_bf16 v[72:75], v[64:67], a[80:83], v[72:75]
    v_xor_b32 v79, 192, v77
    s_add_u32 m0, s18, 7168
    s_add_u32 s3, s98, 229376
    buffer_load_dwordx4 v79, s[40:43], s3 offen  lds
    v_mul_u32_u24_sdwa v64, v59, v12 dst_sel:DWORD dst_unused:UNUSED_PAD src0_sel:WORD_0 src1_sel:DWORD
    v_mul_u32_u24_sdwa v65, v59, v13 dst_sel:DWORD dst_unused:UNUSED_PAD src0_sel:WORD_0 src1_sel:DWORD
    v_mul_u32_u24_sdwa v66, v59, v14 dst_sel:DWORD dst_unused:UNUSED_PAD src0_sel:WORD_0 src1_sel:DWORD
    v_mul_u32_u24_sdwa v67, v59, v15 dst_sel:DWORD dst_unused:UNUSED_PAD src0_sel:WORD_0 src1_sel:DWORD
    s_waitcnt vmcnt(18)
    v_mfma_f32_16x16x32_bf16 v[72:75], v[68:71], a[84:87], v[72:75]
    v_mul_u32_u24_sdwa v68, v59, v12 dst_sel:DWORD dst_unused:UNUSED_PAD src0_sel:WORD_1 src1_sel:DWORD
    v_mul_u32_u24_sdwa v69, v59, v13 dst_sel:DWORD dst_unused:UNUSED_PAD src0_sel:WORD_1 src1_sel:DWORD
    v_mul_u32_u24_sdwa v70, v59, v14 dst_sel:DWORD dst_unused:UNUSED_PAD src0_sel:WORD_1 src1_sel:DWORD
    v_mul_u32_u24_sdwa v71, v59, v15 dst_sel:DWORD dst_unused:UNUSED_PAD src0_sel:WORD_1 src1_sel:DWORD
    s_waitcnt vmcnt(17)
    v_mfma_f32_16x16x32_bf16 v[72:75], v[64:67], a[88:91], v[72:75]
    v_mul_u32_u24_sdwa v64, v60, v12 dst_sel:DWORD dst_unused:UNUSED_PAD src0_sel:WORD_0 src1_sel:DWORD
    v_mul_u32_u24_sdwa v65, v60, v13 dst_sel:DWORD dst_unused:UNUSED_PAD src0_sel:WORD_0 src1_sel:DWORD
    v_mul_u32_u24_sdwa v66, v60, v14 dst_sel:DWORD dst_unused:UNUSED_PAD src0_sel:WORD_0 src1_sel:DWORD
    v_mul_u32_u24_sdwa v67, v60, v15 dst_sel:DWORD dst_unused:UNUSED_PAD src0_sel:WORD_0 src1_sel:DWORD
    s_waitcnt vmcnt(16)
    v_mfma_f32_16x16x32_bf16 v[72:75], v[68:71], a[92:95], v[72:75]
    v_mul_u32_u24_sdwa v68, v60, v12 dst_sel:DWORD dst_unused:UNUSED_PAD src0_sel:WORD_1 src1_sel:DWORD
    v_mul_u32_u24_sdwa v69, v60, v13 dst_sel:DWORD dst_unused:UNUSED_PAD src0_sel:WORD_1 src1_sel:DWORD
    v_mul_u32_u24_sdwa v70, v60, v14 dst_sel:DWORD dst_unused:UNUSED_PAD src0_sel:WORD_1 src1_sel:DWORD
    v_mul_u32_u24_sdwa v71, v60, v15 dst_sel:DWORD dst_unused:UNUSED_PAD src0_sel:WORD_1 src1_sel:DWORD
    s_waitcnt vmcnt(15)
    v_mfma_f32_16x16x32_bf16 v[72:75], v[64:67], a[96:99], v[72:75]
    v_mul_u32_u24_sdwa v64, v61, v12 dst_sel:DWORD dst_unused:UNUSED_PAD src0_sel:WORD_0 src1_sel:DWORD
    v_mul_u32_u24_sdwa v65, v61, v13 dst_sel:DWORD dst_unused:UNUSED_PAD src0_sel:WORD_0 src1_sel:DWORD
    v_mul_u32_u24_sdwa v66, v61, v14 dst_sel:DWORD dst_unused:UNUSED_PAD src0_sel:WORD_0 src1_sel:DWORD
    v_mul_u32_u24_sdwa v67, v61, v15 dst_sel:DWORD dst_unused:UNUSED_PAD src0_sel:WORD_0 src1_sel:DWORD
    s_waitcnt vmcnt(14)
    v_mfma_f32_16x16x32_bf16 v[72:75], v[68:71], a[100:103], v[72:75]
    v_mul_u32_u24_sdwa v68, v61, v12 dst_sel:DWORD dst_unused:UNUSED_PAD src0_sel:WORD_1 src1_sel:DWORD
    v_mul_u32_u24_sdwa v69, v61, v13 dst_sel:DWORD dst_unused:UNUSED_PAD src0_sel:WORD_1 src1_sel:DWORD
    v_mul_u32_u24_sdwa v70, v61, v14 dst_sel:DWORD dst_unused:UNUSED_PAD src0_sel:WORD_1 src1_sel:DWORD
    v_mul_u32_u24_sdwa v71, v61, v15 dst_sel:DWORD dst_unused:UNUSED_PAD src0_sel:WORD_1 src1_sel:DWORD
    s_waitcnt vmcnt(13)
    v_mfma_f32_16x16x32_bf16 v[72:75], v[64:67], a[104:107], v[72:75]
    v_mul_u32_u24_sdwa v64, v62, v12 dst_sel:DWORD dst_unused:UNUSED_PAD src0_sel:WORD_0 src1_sel:DWORD
    v_mul_u32_u24_sdwa v65, v62, v13 dst_sel:DWORD dst_unused:UNUSED_PAD src0_sel:WORD_0 src1_sel:DWORD
    v_mul_u32_u24_sdwa v66, v62, v14 dst_sel:DWORD dst_unused:UNUSED_PAD src0_sel:WORD_0 src1_sel:DWORD
    v_mul_u32_u24_sdwa v67, v62, v15 dst_sel:DWORD dst_unused:UNUSED_PAD src0_sel:WORD_0 src1_sel:DWORD
    s_waitcnt vmcnt(12)
    v_mfma_f32_16x16x32_bf16 v[72:75], v[68:71], a[108:111], v[72:75]
    v_mul_u32_u24_sdwa v68, v62, v12 dst_sel:DWORD dst_unused:UNUSED_PAD src0_sel:WORD_1 src1_sel:DWORD
    v_mul_u32_u24_sdwa v69, v62, v13 dst_sel:DWORD dst_unused:UNUSED_PAD src0_sel:WORD_1 src1_sel:DWORD
    v_mul_u32_u24_sdwa v70, v62, v14 dst_sel:DWORD dst_unused:UNUSED_PAD src0_sel:WORD_1 src1_sel:DWORD
    v_mul_u32_u24_sdwa v71, v62, v15 dst_sel:DWORD dst_unused:UNUSED_PAD src0_sel:WORD_1 src1_sel:DWORD
    s_waitcnt vmcnt(11)
    v_mfma_f32_16x16x32_bf16 v[72:75], v[64:67], a[112:115], v[72:75]
    v_mul_u32_u24_sdwa v64, v63, v12 dst_sel:DWORD dst_unused:UNUSED_PAD src0_sel:WORD_0 src1_sel:DWORD
    v_mul_u32_u24_sdwa v65, v63, v13 dst_sel:DWORD dst_unused:UNUSED_PAD src0_sel:WORD_0 src1_sel:DWORD
    v_mul_u32_u24_sdwa v66, v63, v14 dst_sel:DWORD dst_unused:UNUSED_PAD src0_sel:WORD_0 src1_sel:DWORD
    v_mul_u32_u24_sdwa v67, v63, v15 dst_sel:DWORD dst_unused:UNUSED_PAD src0_sel:WORD_0 src1_sel:DWORD
    s_waitcnt vmcnt(10)
    v_mfma_f32_16x16x32_bf16 v[72:75], v[68:71], a[116:119], v[72:75]
    v_mul_u32_u24_sdwa v68, v63, v12 dst_sel:DWORD dst_unused:UNUSED_PAD src0_sel:WORD_1 src1_sel:DWORD
    v_mul_u32_u24_sdwa v69, v63, v13 dst_sel:DWORD dst_unused:UNUSED_PAD src0_sel:WORD_1 src1_sel:DWORD
    v_mul_u32_u24_sdwa v70, v63, v14 dst_sel:DWORD dst_unused:UNUSED_PAD src0_sel:WORD_1 src1_sel:DWORD
    v_mul_u32_u24_sdwa v71, v63, v15 dst_sel:DWORD dst_unused:UNUSED_PAD src0_sel:WORD_1 src1_sel:DWORD
    s_waitcnt vmcnt(9)
    v_mfma_f32_16x16x32_bf16 v[72:75], v[64:67], a[120:123], v[72:75]
    s_waitcnt vmcnt(8)
    v_mfma_f32_16x16x32_bf16 v[72:75], v[68:71], a[124:127], v[72:75]
    s_nop 7
    v_cvt_pk_bf16_f32 v40, v72, v73
    v_cvt_pk_bf16_f32 v41, v74, v75
    ds_write_b64 v80, v[40:41]
    s_waitcnt vmcnt(0)
    ds_read_b128 v[100:103], v84 offset:0
    ds_read_b128 v[116:119], v84 offset:4096
    ds_read_b128 v[104:107], v85 offset:0
    ds_read_b128 v[120:123], v85 offset:4096
    ds_read_b128 v[108:111], v86 offset:0
    ds_read_b128 v[124:127], v86 offset:4096
    ds_read_b128 v[112:115], v87 offset:0
    ds_read_b128 v[128:131], v87 offset:4096
    s_waitcnt lgkmcnt(8)
    s_barrier
    ds_read_b128 v[132:135], v81 offset:0
    ds_read_b128 v[136:139], v81 offset:64
    ds_read_b128 v[140:143], v81 offset:128
    ds_read_b128 v[144:147], v81 offset:192
    s_waitcnt lgkmcnt(3)
    v_mfma_f32_16x16x32_bf16 v[148:151], v[132:135], v[100:103], 0
    v_mfma_f32_16x16x32_bf16 v[152:155], v[132:135], v[116:119], 0
    s_waitcnt lgkmcnt(2)
    v_mfma_f32_16x16x32_bf16 v[148:151], v[136:139], v[104:107], v[148:151]
    v_mfma_f32_16x16x32_bf16 v[152:155], v[136:139], v[120:123], v[152:155]
    s_waitcnt lgkmcnt(1)
    v_mfma_f32_16x16x32_bf16 v[148:151], v[140:143], v[108:111], v[148:151]
    v_mfma_f32_16x16x32_bf16 v[152:155], v[140:143], v[124:127], v[152:155]
    s_waitcnt lgkmcnt(0)
    v_mfma_f32_16x16x32_bf16 v[148:151], v[144:147], v[112:115], v[148:151]
    v_mfma_f32_16x16x32_bf16 v[152:155], v[144:147], v[128:131], v[152:155]
    s_nop 6
    v_pk_add_f32 v[148:149], v[148:149], v[150:151]
    v_pk_add_f32 v[152:153], v[152:153], v[154:155]
    v_add_f32 v148, v148, v149
    v_add_f32 v152, v152, v153
    v_cndmask_b32 v148, v148, v152, vcc
    v_mul_f32 v148, s19, v148
    v_cvt_pk_bf16_f32 v148, v148, v148
    ds_write_b16 v88, v148
    s_cmp_lg_u32 s30, 0
    s_waitcnt lgkmcnt(0)
    s_barrier
    s_cbranch_scc1 L_W_nopub
    ds_read_b128 v[40:43], v96
    s_mov_b32 exec_hi, 0
    s_waitcnt lgkmcnt(0)
    buffer_store_dwordx4 v[40:43], v89, s[32:35], s20 offen sc1
    v_add3_u32 v44, v40, v41, v42
    v_add_u32 v44, v44, v43
    s_nop 1
    v_add_u32_dpp v44, v44, v44 row_ror:8 row_mask:0xf bank_mask:0xf
    s_nop 1
    v_add_u32_dpp v44, v44, v44 row_ror:4 row_mask:0xf bank_mask:0xf
    s_nop 1
    v_add_u32_dpp v44, v44, v44 row_ror:2 row_mask:0xf bank_mask:0xf
    s_nop 1
    v_add_u32_dpp v44, v44, v44 row_ror:1 row_mask:0xf bank_mask:0xf
    s_mov_b32 exec_lo, 0x000f000f
    s_waitcnt vmcnt(0)
    buffer_store_dwordx4 v[44:47], v97, s[32:35], s22 offen sc1
    s_mov_b64 exec, -1
L_W_nopub:
    s_mov_b32 s44, s12
    s_mov_b32 s45, s13
    s_mov_b32 s46, 4194304
    s_mov_b32 s47, 0x20000
    s_mov_b32 s48, s14
    s_mov_b32 s49, s15
    s_mov_b32 s50, 4194304
    s_mov_b32 s51, 0x20000
    v_and_b32 v6, 1, v3
    v_lshlrev_b32 v6, 1, v6
    v_xor_b32 v6, v6, v2
    s_lshl_b32 s31, s30, 3
    s_and_b32 s31, s31, 8
    v_xor_b32 v6, s31, v6
    v_lshlrev_b32 v6, 4, v6
    v_lshl_or_b32 v48, v3, 13, v6
    v_lshlrev_b32 v6, 2, v3
    v_xor_b32 v6, v6, v2
    v_lshlrev_b32 v6, 4, v6
    v_lshl_or_b32 v49, v3, 10, v6
    s_lshl_b32 s31, s53, 17
    s_lshl_b32 s3, s30, 8
    s_add_u32 s31, s31, s3
    v_add_u32 v49, s31, v49
    s_lshl_b32 s23, s54, 15
    s_mul_i32 s6, s30, 24576
    v_bfe_u32 v52, v1, 2, 2
    v_and_b32 v53, 1, v3
    v_lshlrev_b32 v7, 2, v52
    v_lshl_or_b32 v7, v53, 1, v7
    v_bfe_u32 v53, v1, 1, 1
    v_xor_b32 v7, v7, v53
    v_and_b32 v53, 1, v1
    v_lshlrev_b32 v53, 3, v53
    v_lshlrev_b32 v6, 4, v52
    v_add_u32 v6, v6, v3
    v_lshl_or_b32 v6, v6, 8, v53
    v_add_u32 v6, 98304, v6
    s_lshl_b32 s31, s30, 2
    v_xor_b32 v54, s31, v7
    v_lshl_add_u32 v50, v54, 4, v6
    v_xor_b32 v54, 2, v54
    v_lshl_add_u32 v51, v54, 4, v6
    v_lshlrev_b32 v6, 11, v3
    v_lshl_or_b32 v6, v52, 8, v6
    v_or_b32 v6, v6, v53
    v_add_u32 v6, s6, v6
    v_lshlrev_b32 v7, 4, v7
    v_xor_b32 v52, 0, v7
    v_add_u32 v52, v52, v6
    v_xor_b32 v53, 32, v7
    v_add_u32 v53, v53, v6
    v_xor_b32 v54, 64, v7
    v_add_u32 v54, v54, v6
    v_xor_b32 v55, 96, v7
    v_add_u32 v55, v55, v6
    v_xor_b32 v56, 128, v7
    v_add_u32 v56, v56, v6
    v_xor_b32 v57, 160, v7
    v_add_u32 v57, v57, v6
    v_xor_b32 v58, 192, v7
    v_add_u32 v58, v58, v6
    v_xor_b32 v59, 224, v7
    v_add_u32 v59, v59, v6
    s_lshr_b32 s55, s30, 1
    s_lshl_b32 s31, s55, 15
    s_lshl_b32 s3, s53, 4
    s_add_u32 s31, s31, s3
    s_add_u32 s31, s31, 69632
    v_lshlrev_b32 v64, 9, v1
    v_add_u32 v64, s31, v64
    s_lshl_b32 s92, s52, 9
    s_add_u32 s92, s92, s3
    s_add_u32 s92, s92, 69640
    v_mul_u32_u24 v65, 2048, v3
    v_lshl_add_u32 v65, v2, 4, v65
    s_mul_i32 s7, s52, 33024
    s_mul_i32 s31, s30, 8192
    s_add_u32 s7, s7, s31
    s_add_u32 s7, s7, 524288
    v_add_u32 v6, 11, v2
    v_mul_u32_u24 v6, 37, v6
    v_add_u32 v6, s56, v6
    v_and_b32 v7, 3, v6
    v_lshlrev_b32 v7, v7, 1
    v_bfe_i32 v68, v6, 2, 1
    v_and_b32 v68, 15, v68
    v_xor_b32 v7, v7, v68
    v_bfe_u32 v6, v6, 3, 4
    v_lshl_or_b32 v6, v6, 16, v7
    v_not_b32 v6, v6
    v_lshrrev_b32 v68, 0, v6
    v_and_b32 v68, 0x10001, v68
    v_lshrrev_b32 v69, 1, v6
    v_and_b32 v69, 0x10001, v69
    v_lshrrev_b32 v70, 2, v6
    v_and_b32 v70, 0x10001, v70
    v_lshrrev_b32 v71, 3, v6
    v_and_b32 v71, 0x10001, v71
    s_lshl_b32 s31, s30, 8
    s_add_u32 s31, s31, 144896
    v_lshl_add_u32 v158, v1, 1, s31
    v_bfe_u32 v6, v1, 3, 1
    v_lshlrev_b32 v6, 7, v6
    v_lshl_add_u32 v6, v3, 4, v6
    s_and_b32 s3, s30, 1
    s_lshl_b32 s3, s3, 6
    s_add_u32 s31, s31, s3
    v_add_u32 v159, s31, v6
    v_lshrrev_b32 v6, 5, v1
    v_lshlrev_b32 v6, 1, v6
    s_lshl_b32 s31, s55, 2
    s_and_b32 s3, s30, 1
    s_add_u32 s31, s31, s3
    v_add_u32 v6, s31, v6
    v_mul_u32_u24 v6, 272, v6
    v_lshl_add_u32 v6, v2, 4, v6
    v_and_b32 v7, 1, v3
    v_lshl_add_u32 v6, v7, 3, v6
    v_add_u32 v148, 145920, v6
    v_lshrrev_b32 v6, 3, v2
    v_lshlrev_b32 v6, 2, v6
    v_and_or_b32 v6, v2, 3, v6
    v_mul_u32_u24 v6, 272, v6
    v_lshl_add_u32 v6, v3, 4, v6
    v_add_u32 v149, 145920, v6
    v_lshrrev_b32 v6, 5, v1
    v_mul_u32_u24 v6, 272, v6
    v_lshl_add_u32 v6, v7, 5, v6
    s_lshl_b32 s31, s30, 6
    s_add_u32 s31, s31, 148480
    v_add_u32 v150, s31, v6
    v_bfe_u32 v7, v2, 1, 1
    v_lshl_add_u32 v150, v7, 4, v150
    v_lshrrev_b32 v6, 2, v2
    v_lshl_add_u32 v150, v6, 2, v150
    v_and_b32 v6, 1, v1
    v_lshl_add_u32 v150, v6, 1, v150
    v_mul_u32_u24 v6, 272, v6
    v_lshl_add_u32 v6, v7, 4, v6
    v_mul_u32_u24 v154, 0xaaaa, v7
    v_add_u32 v154, 0x4444, v154
    v_and_b32 v7, 1, v3
    v_lshl_add_u32 v6, v7, 5, v6
    v_add_u32 v6, 148480, v6
    v_lshrrev_b32 v7, 1, v3
    v_add_u32 v7, s54, v7
    v_and_b32 v152, 3, v7
    v_xor_b32 v153, 2, v152
    v_lshl_add_u32 v152, v152, 6, v6
    v_lshl_add_u32 v153, v153, 6, v6
    v_mov_b32 v184, 0
    v_mov_b32 v185, 0
    v_mov_b32 v186, 0
    v_mov_b32 v187, 0
    v_mov_b32 v188, 0
    v_mov_b32 v189, 0
    v_mov_b32 v190, 0
    v_mov_b32 v191, 0
    v_mov_b32 v6, 149024
    ds_write_b128 v6, v[184:187]
    v_lshrrev_b32 v7, 2, v2
    v_cmp_eq_u32 vcc, 0, v7
    s_nop 1
    v_cndmask_b32 v192, v6, v152, vcc
    v_cndmask_b32 v193, v6, v153, vcc
    v_cmp_eq_u32 vcc, 1, v7
    s_nop 1
    v_cndmask_b32 v194, v6, v152, vcc
    v_cndmask_b32 v195, v6, v153, vcc
    v_cmp_eq_u32 vcc, 2, v7
    s_nop 1
    v_cndmask_b32 v196, v6, v152, vcc
    v_cndmask_b32 v197, v6, v153, vcc
    v_cmp_eq_u32 vcc, 3, v7
    s_nop 1
    v_cndmask_b32 v198, v6, v152, vcc
    v_cndmask_b32 v199, v6, v153, vcc
    v_mov_b32 v157, 0xffffff00
    v_lshrrev_b32 v156, 3, v2
    v_mul_u32_u24 v156, 32896, v156
    v_and_b32 v6, 7, v2
    v_lshl_add_u32 v156, v6, 4, v156
    v_mul_u32_u24 v6, 65792, v3
    v_add_u32 v156, v156, v6
    s_mul_i32 s88, s30, 263168
    s_lshl_b32 s31, s52, 7
    s_add_u32 s88, s88, s31
    s_add_u32 s88, s88, 4751360
    v_lshrrev_b32 v160, 1, v0
    v_lshlrev_b32 v160, 7, v160
    v_and_b32 v6, 1, v0
    v_lshl_add_u32 v160, v6, 4, v160
    s_mul_i32 s89, s53, 32896
    s_lshl_b32 s31, s54, 5
    s_add_u32 s89, s89, s31
    s_add_u32 s89, s89, 4751360
    s_add_u32 s90, s89, 16384
    s_lshr_b32 s31, s53, 1
    s_lshl_b32 s31, s31, 5
    s_and_b32 s3, s53, 1
    s_lshl_b32 s3, s3, 3
    s_add_u32 s31, s31, s3
    s_lshl_b32 s3, s54, 1
    s_add_u32 s31, s31, s3
    s_lshl_b32 s31, s31, 1
    v_and_b32 v161, 1, v1
    v_lshlrev_b32 v161, 10, v161
    v_bfe_u32 v6, v1, 1, 1
    v_lshl_add_u32 v161, v6, 5, v161
    v_add_u32 v161, s31, v161
    global_load_dword v162, v161, s[4:5]
    v_cmp_gt_u32 vcc, 224, v0
    s_mov_b64 s[16:17], vcc
    v_and_b32 v6, 1, v3
    v_lshlrev_b32 v6, 7, v6
    v_lshrrev_b32 v7, 5, v1
    v_lshl_add_u32 v6, v7, 6, v6
    v_and_b32 v7, 1, v1
    v_lshl_add_u32 v6, v7, 4, v6
    s_lshl_b32 s31, s30, 2
    s_add_u32 s31, s31, 149504
    v_add_u32 v163, s31, v6
    v_and_b32 v6, 3, v1
    v_lshlrev_b32 v6, 5, v6
    v_add_u32 v164, 149504, v6
    s_and_b32 s91, s52, 0xfc
    s_lshl_b32 s91, s91, 7
    s_add_u32 s91, s91, 135168
    s_mov_b32 s62, 0
L_W_go:
    buffer_load_dword v6, v5, s[32:35], s91 offen sc1
    s_add_u32 s62, s62, 1
    s_waitcnt vmcnt(0)
    v_cmp_ne_u32 vcc, s57, v6
    s_cmp_lt_u32 s62, 30000
    s_cbranch_scc0 L_W_went
    s_cbranch_vccnz L_W_go
L_W_went:
    s_or_b32 s31, s52, s30
    s_cmp_eq_u32 s31, 0
    s_cselect_b32 s91, 0, 6291456
    v_add_u32 v8, 1, v8
    v_xor_b32 v6, 0, v49
    s_add_u32 m0, s6, 0
    s_add_u32 s3, s23, 0
    buffer_load_dwordx4 v6, s[48:51], s3 offen  lds
    v_xor_b32 v7, 0, v49
    s_add_u32 m0, s6, 1024
    s_add_u32 s3, s23, 4096
    buffer_load_dwordx4 v7, s[48:51], s3 offen  lds
    v_xor_b32 v6, 32, v49
    s_add_u32 m0, s6, 2048
    s_add_u32 s3, s23, 8192
    buffer_load_dwordx4 v6, s[48:51], s3 offen  lds
    v_xor_b32 v7, 32, v49
    s_add_u32 m0, s6, 3072
    s_add_u32 s3, s23, 12288
    buffer_load_dwordx4 v7, s[48:51], s3 offen  lds
    v_xor_b32 v6, 0, v49
    s_add_u32 m0, s6, 4096
    s_add_u32 s3, s23, 16384
    buffer_load_dwordx4 v6, s[48:51], s3 offen  lds
    v_xor_b32 v7, 0, v49
    s_add_u32 m0, s6, 5120
    s_add_u32 s3, s23, 20480
    buffer_load_dwordx4 v7, s[48:51], s3 offen  lds
    v_xor_b32 v6, 32, v49
    s_add_u32 m0, s6, 6144
    s_add_u32 s3, s23, 24576
    buffer_load_dwordx4 v6, s[48:51], s3 offen  lds
    v_xor_b32 v7, 32, v49
    s_add_u32 m0, s6, 7168
    s_add_u32 s3, s23, 28672
    buffer_load_dwordx4 v7, s[48:51], s3 offen  lds
    v_xor_b32 v6, 0, v48
    s_add_u32 m0, s18, 0
    s_add_u32 s3, s98, 0
    buffer_load_dwordx4 v6, s[44:47], s3 offen nt lds
    v_xor_b32 v7, 0, v48
    s_add_u32 m0, s18, 1024
    s_add_u32 s3, s98, 32768
    buffer_load_dwordx4 v7, s[44:47], s3 offen nt lds
    v_xor_b32 v6, 0, v48
    s_add_u32 m0, s18, 2048
    s_add_u32 s3, s98, 65536
    buffer_load_dwordx4 v6, s[44:47], s3 offen nt lds
    v_xor_b32 v7, 0, v48
    s_add_u32 m0, s18, 3072
    s_add_u32 s3, s98, 98304
    buffer_load_dwordx4 v7, s[44:47], s3 offen nt lds
    v_xor_b32 v6, 64, v48
    s_add_u32 m0, s18, 4096
    s_add_u32 s3, s98, 131072
    buffer_load_dwordx4 v6, s[44:47], s3 offen nt lds
    v_xor_b32 v7, 64, v48
    s_add_u32 m0, s18, 5120
    s_add_u32 s3, s98, 163840
    buffer_load_dwordx4 v7, s[44:47], s3 offen nt lds
    v_xor_b32 v6, 64, v48
    s_add_u32 m0, s18, 6144
    s_add_u32 s3, s98, 196608
    buffer_load_dwordx4 v6, s[44:47], s3 offen nt lds
    v_xor_b32 v7, 64, v48
    s_add_u32 m0, s18, 7168
    s_add_u32 s3, s98, 229376
    buffer_load_dwordx4 v7, s[44:47], s3 offen nt lds
    s_add_u32 s23, s23, 0x8000
    s_and_b32 s23, s23, 0x1ffff
    v_xor_b32 v6, 0, v49
    s_add_u32 m0, s6, 8192
    s_add_u32 s3, s23, 0
    buffer_load_dwordx4 v6, s[48:51], s3 offen  lds
    v_xor_b32 v7, 0, v49
    s_add_u32 m0, s6, 9216
    s_add_u32 s3, s23, 4096
    buffer_load_dwordx4 v7, s[48:51], s3 offen  lds
    v_xor_b32 v6, 32, v49
    s_add_u32 m0, s6, 10240
    s_add_u32 s3, s23, 8192
    buffer_load_dwordx4 v6, s[48:51], s3 offen  lds
    v_xor_b32 v7, 32, v49
    s_add_u32 m0, s6, 11264
    s_add_u32 s3, s23, 12288
    buffer_load_dwordx4 v7, s[48:51], s3 offen  lds
    v_xor_b32 v6, 0, v49
    s_add_u32 m0, s6, 12288
    s_add_u32 s3, s23, 16384
    buffer_load_dwordx4 v6, s[48:51], s3 offen  lds
    v_xor_b32 v7, 0, v49
    s_add_u32 m0, s6, 13312
    s_add_u32 s3, s23, 20480
    buffer_load_dwordx4 v7, s[48:51], s3 offen  lds
    v_xor_b32 v6, 32, v49
    s_add_u32 m0, s6, 14336
    s_add_u32 s3, s23, 24576
    buffer_load_dwordx4 v6, s[48:51], s3 offen  lds
    v_xor_b32 v7, 32, v49
    s_add_u32 m0, s6, 15360
    s_add_u32 s3, s23, 28672
    buffer_load_dwordx4 v7, s[48:51], s3 offen  lds
    s_waitcnt vmcnt(16)
    ds_read_b64_tr_b16 a[0:1], v52 offset:0
    ds_read_b64_tr_b16 a[2:3], v52 offset:1024
    ds_read_b64_tr_b16 a[16:17], v53 offset:0
    ds_read_b64_tr_b16 a[18:19], v53 offset:1024
    ds_read_b64_tr_b16 a[32:33], v54 offset:0
    ds_read_b64_tr_b16 a[34:35], v54 offset:1024
    ds_read_b64_tr_b16 a[48:49], v55 offset:0
    ds_read_b64_tr_b16 a[50:51], v55 offset:1024
    s_waitcnt lgkmcnt(6)
    ds_read_b64_tr_b16 a[64:65], v56 offset:0
    ds_read_b64_tr_b16 a[66:67], v56 offset:1024
    ds_read_b64_tr_b16 a[80:81], v57 offset:0
    ds_read_b64_tr_b16 a[82:83], v57 offset:1024
    ds_read_b64_tr_b16 a[96:97], v58 offset:0
    ds_read_b64_tr_b16 a[98:99], v58 offset:1024
    ds_read_b64_tr_b16 a[112:113], v59 offset:0
    ds_read_b64_tr_b16 a[114:115], v59 offset:1024
    s_waitcnt lgkmcnt(6)
    s_add_u32 s23, s23, 0x8000
    s_and_b32 s23, s23, 0x1ffff
    v_xor_b32 v6, 0, v49
    s_add_u32 m0, s6, 16384
    s_add_u32 s3, s23, 0
    buffer_load_dwordx4 v6, s[48:51], s3 offen  lds
    v_xor_b32 v7, 0, v49
    s_add_u32 m0, s6, 17408
    s_add_u32 s3, s23, 4096
    buffer_load_dwordx4 v7, s[48:51], s3 offen  lds
    v_xor_b32 v6, 32, v49
    s_add_u32 m0, s6, 18432
    s_add_u32 s3, s23, 8192
    buffer_load_dwordx4 v6, s[48:51], s3 offen  lds
    v_xor_b32 v7, 32, v49
    s_add_u32 m0, s6, 19456
    s_add_u32 s3, s23, 12288
    buffer_load_dwordx4 v7, s[48:51], s3 offen  lds
    v_xor_b32 v6, 0, v49
    s_add_u32 m0, s6, 20480
    s_add_u32 s3, s23, 16384
    buffer_load_dwordx4 v6, s[48:51], s3 offen  lds
    v_xor_b32 v7, 0, v49
    s_add_u32 m0, s6, 21504
    s_add_u32 s3, s23, 20480
    buffer_load_dwordx4 v7, s[48:51], s3 offen  lds
    v_xor_b32 v6, 32, v49
    s_add_u32 m0, s6, 22528
    s_add_u32 s3, s23, 24576
    buffer_load_dwordx4 v6, s[48:51], s3 offen  lds
    v_xor_b32 v7, 32, v49
    s_add_u32 m0, s6, 23552
    s_add_u32 s3, s23, 28672
    buffer_load_dwordx4 v7, s[48:51], s3 offen  lds
    s_waitcnt vmcnt(16)
    s_barrier
    ds_read_b64_tr_b16 a[128:129], v50 offset:0
    ds_read_b64_tr_b16 a[130:131], v50 offset:16384
    ds_read_b64_tr_b16 a[132:133], v50 offset:1024
    ds_read_b64_tr_b16 a[134:135], v50 offset:17408
    ds_read_b64_tr_b16 a[136:137], v50 offset:2048
    ds_read_b64_tr_b16 a[138:139], v50 offset:18432
    ds_read_b64_tr_b16 a[140:141], v50 offset:3072
    ds_read_b64_tr_b16 a[142:143], v50 offset:19456
    s_waitcnt lgkmcnt(6)
    ds_read_b64_tr_b16 a[144:145], v51 offset:0
    ds_read_b64_tr_b16 a[146:147], v51 offset:16384
    ds_read_b64_tr_b16 a[148:149], v51 offset:1024
    ds_read_b64_tr_b16 a[150:151], v51 offset:17408
    ds_read_b64_tr_b16 a[152:153], v51 offset:2048
    ds_read_b64_tr_b16 a[154:155], v51 offset:18432
    ds_read_b64_tr_b16 a[156:157], v51 offset:3072
    ds_read_b64_tr_b16 a[158:159], v51 offset:19456
    s_waitcnt lgkmcnt(6)
    s_add_u32 s23, s23, 0x8000
    s_and_b32 s23, s23, 0x1ffff
    v_xor_b32 v6, 0, v49
    s_add_u32 m0, s6, 0
    s_add_u32 s3, s23, 0
    buffer_load_dwordx4 v6, s[48:51], s3 offen  lds
    v_xor_b32 v7, 0, v49
    s_add_u32 m0, s6, 1024
    s_add_u32 s3, s23, 4096
    buffer_load_dwordx4 v7, s[48:51], s3 offen  lds
    v_xor_b32 v6, 32, v49
    s_add_u32 m0, s6, 2048
    s_add_u32 s3, s23, 8192
    buffer_load_dwordx4 v6, s[48:51], s3 offen  lds
    v_xor_b32 v7, 32, v49
    s_add_u32 m0, s6, 3072
    s_add_u32 s3, s23, 12288
    buffer_load_dwordx4 v7, s[48:51], s3 offen  lds
    v_xor_b32 v6, 0, v49
    s_add_u32 m0, s6, 4096
    s_add_u32 s3, s23, 16384
    buffer_load_dwordx4 v6, s[48:51], s3 offen  lds
    v_xor_b32 v7, 0, v49
    s_add_u32 m0, s6, 5120
    s_add_u32 s3, s23, 20480
    buffer_load_dwordx4 v7, s[48:51], s3 offen  lds
    v_xor_b32 v6, 32, v49
    s_add_u32 m0, s6, 6144
    s_add_u32 s3, s23, 24576
    buffer_load_dwordx4 v6, s[48:51], s3 offen  lds
    v_xor_b32 v7, 32, v49
    s_add_u32 m0, s6, 7168
    s_add_u32 s3, s23, 28672
    buffer_load_dwordx4 v7, s[48:51], s3 offen  lds
    s_getpc_b64 s[100:101]
L_pf2:
    v_lshrrev_b32 v6, 2, v0
    v_lshlrev_b32 v6, 7, v6
    v_min_u32 v6, L_W_last-L_W_staged, v6
    v_add_u32 v6, L_W_staged-L_pf2, v6
    s_mov_b32 exec_lo, 0x11111111
    s_mov_b32 exec_hi, 0x11111111
    global_load_dword v9, v6, s[100:101]
    s_mov_b64 exec, -1
    buffer_load_dword v6, v5, s[32:35], s92 offen sc1
    s_waitcnt vmcnt(18)
    ds_read_b64_tr_b16 a[4:5], v52 offset:8192
    ds_read_b64_tr_b16 a[6:7], v52 offset:9216
    ds_read_b64_tr_b16 a[20:21], v53 offset:8192
    ds_read_b64_tr_b16 a[22:23], v53 offset:9216
    ds_read_b64_tr_b16 a[36:37], v54 offset:8192
    ds_read_b64_tr_b16 a[38:39], v54 offset:9216
    ds_read_b64_tr_b16 a[52:53], v55 offset:8192
    ds_read_b64_tr_b16 a[54:55], v55 offset:9216
    s_waitcnt lgkmcnt(6)
    ds_read_b64_tr_b16 a[68:69], v56 offset:8192
    ds_read_b64_tr_b16 a[70:71], v56 offset:9216
    ds_read_b64_tr_b16 a[84:85], v57 offset:8192
    ds_read_b64_tr_b16 a[86:87], v57 offset:9216
    ds_read_b64_tr_b16 a[100:101], v58 offset:8192
    ds_read_b64_tr_b16 a[102:103], v58 offset:9216
    ds_read_b64_tr_b16 a[116:117], v59 offset:8192
    ds_read_b64_tr_b16 a[118:119], v59 offset:9216
    s_waitcnt lgkmcnt(6)
L_W_staged:
    s_mov_b32 s62, 0
    s_waitcnt vmcnt(0)
    v_cmp_ne_u32 vcc, s57, v6
    s_cbranch_vccz L_W_seen
    buffer_load_dword v6, v5, s[32:35], s92 offen sc1
    ds_read_b64_tr_b16 a[8:9], v52 offset:16384
    ds_read_b64_tr_b16 a[10:11], v52 offset:17408
    ds_read_b64_tr_b16 a[24:25], v53 offset:16384
    ds_read_b64_tr_b16 a[26:27], v53 offset:17408
    ds_read_b64_tr_b16 a[40:41], v54 offset:16384
    ds_read_b64_tr_b16 a[42:43], v54 offset:17408
    ds_read_b64_tr_b16 a[56:57], v55 offset:16384
    ds_read_b64_tr_b16 a[58:59], v55 offset:17408
    s_waitcnt lgkmcnt(6)
    ds_read_b64_tr_b16 a[72:73], v56 offset:16384
    ds_read_b64_tr_b16 a[74:75], v56 offset:17408
    ds_read_b64_tr_b16 a[88:89], v57 offset:16384
    ds_read_b64_tr_b16 a[90:91], v57 offset:17408
    ds_read_b64_tr_b16 a[104:105], v58 offset:16384
    ds_read_b64_tr_b16 a[106:107], v58 offset:17408
    ds_read_b64_tr_b16 a[120:121], v59 offset:16384
    ds_read_b64_tr_b16 a[122:123], v59 offset:17408
    s_waitcnt lgkmcnt(6)
    ds_read_b64_tr_b16 a[12:13], v52 offset:0
    ds_read_b64_tr_b16 a[14:15], v52 offset:1024
    ds_read_b64_tr_b16 a[28:29], v53 offset:0
    ds_read_b64_tr_b16 a[30:31], v53 offset:1024
    ds_read_b64_tr_b16 a[44:45], v54 offset:0
    ds_read_b64_tr_b16 a[46:47], v54 offset:1024
    ds_read_b64_tr_b16 a[60:61], v55 offset:0
    ds_read_b64_tr_b16 a[62:63], v55 offset:1024
    s_waitcnt lgkmcnt(6)
    ds_read_b64_tr_b16 a[76:77], v56 offset:0
    ds_read_b64_tr_b16 a[78:79], v56 offset:1024
    ds_read_b64_tr_b16 a[92:93], v57 offset:0
    ds_read_b64_tr_b16 a[94:95], v57 offset:1024
    ds_read_b64_tr_b16 a[108:109], v58 offset:0
    ds_read_b64_tr_b16 a[110:111], v58 offset:1024
    ds_read_b64_tr_b16 a[124:125], v59 offset:0
    ds_read_b64_tr_b16 a[126:127], v59 offset:1024
    s_waitcnt lgkmcnt(6)
    s_waitcnt vmcnt(0)
    v_cmp_ne_u32 vcc, s57, v6
    s_cbranch_vccz L_W_poll
L_W_pre:
    buffer_load_dword v6, v5, s[32:35], s92 offen sc1
    s_add_u32 s62, s62, 1
    s_waitcnt vmcnt(0)
    v_cmp_ne_u32 vcc, s57, v6
    s_cmp_lt_u32 s62, 120000
    s_cbranch_scc0 L_W_pred
    s_cbranch_vccnz L_W_pre
L_W_pred:
    s_branch L_W_poll
L_W_seen:
    buffer_load_dwordx4 v[60:63], v64, s[32:35], 0 offen sc1
    ds_read_b64_tr_b16 a[8:9], v52 offset:16384
    ds_read_b64_tr_b16 a[10:11], v52 offset:17408
    ds_read_b64_tr_b16 a[24:25], v53 offset:16384
    ds_read_b64_tr_b16 a[26:27], v53 offset:17408
    ds_read_b64_tr_b16 a[40:41], v54 offset:16384
    ds_read_b64_tr_b16 a[42:43], v54 offset:17408
    ds_read_b64_tr_b16 a[56:57], v55 offset:16384
    ds_read_b64_tr_b16 a[58:59], v55 offset:17408
    s_waitcnt lgkmcnt(6)
    ds_read_b64_tr_b16 a[72:73], v56 offset:16384
    ds_read_b64_tr_b16 a[74:75], v56 offset:17408
    ds_read_b64_tr_b16 a[88:89], v57 offset:16384
    ds_read_b64_tr_b16 a[90:91], v57 offset:17408
    ds_read_b64_tr_b16 a[104:105], v58 offset:16384
    ds_read_b64_tr_b16 a[106:107], v58 offset:17408
    ds_read_b64_tr_b16 a[120:121], v59 offset:16384
    ds_read_b64_tr_b16 a[122:123], v59 offset:17408
    s_waitcnt lgkmcnt(6)
    ds_read_b64_tr_b16 a[12:13], v52 offset:0
    ds_read_b64_tr_b16 a[14:15], v52 offset:1024
    ds_read_b64_tr_b16 a[28:29], v53 offset:0
    ds_read_b64_tr_b16 a[30:31], v53 offset:1024
    ds_read_b64_tr_b16 a[44:45], v54 offset:0
    ds_read_b64_tr_b16 a[46:47], v54 offset:1024
    ds_read_b64_tr_b16 a[60:61], v55 offset:0
    ds_read_b64_tr_b16 a[62:63], v55 offset:1024
    s_waitcnt lgkmcnt(6)
    ds_read_b64_tr_b16 a[76:77], v56 offset:0
    ds_read_b64_tr_b16 a[78:79], v56 offset:1024
    ds_read_b64_tr_b16 a[92:93], v57 offset:0
    ds_read_b64_tr_b16 a[94:95], v57 offset:1024
    ds_read_b64_tr_b16 a[108:109], v58 offset:0
    ds_read_b64_tr_b16 a[110:111], v58 offset:1024
    ds_read_b64_tr_b16 a[124:125], v59 offset:0
    ds_read_b64_tr_b16 a[126:127], v59 offset:1024
    s_waitcnt lgkmcnt(6)
    s_waitcnt vmcnt(0)
    v_cmp_ne_u32 vcc, s57, v62
    s_cbranch_vccz L_W_got
L_W_poll:
    buffer_load_dwordx4 v[60:63], v64, s[32:35], 0 offen sc1
    s_add_u32 s62, s62, 1
    s_waitcnt vmcnt(0)
    v_cmp_ne_u32 vcc, s57, v62
    s_cmp_lt_u32 s62, 120000
    s_cbranch_scc0 L_W_got
    s_cbranch_vccnz L_W_poll
L_W_got:
    s_mov_b32 s62, 0
    v_mov_b32 v147, v60
    s_nop 1
    v_max_f32_dpp v147, v147, v147 row_ror:8 row_mask:0xf bank_mask:0xf
    s_nop 1
    v_max_f32_dpp v147, v147, v147 row_ror:4 row_mask:0xf bank_mask:0xf
    s_nop 1
    v_max_f32_dpp v147, v147, v147 row_ror:2 row_mask:0xf bank_mask:0xf
    s_nop 1
    v_max_f32_dpp v147, v147, v147 row_ror:1 row_mask:0xf bank_mask:0xf
    v_mov_b32 v146, v147
    s_nop 1
    v_permlane16_swap_b32 v147, v146
    v_max_f32 v147, v147, v146
    v_mov_b32 v146, v147
    s_nop 1
    v_permlane32_swap_b32 v147, v146
    v_max_f32 v147, v147, v146
    v_sub_f32 v145, v60, v147
    v_exp_f32 v145, v145
    s_nop 0
    v_mul_f32 v61, v145, v61
    v_cvt_pk_bf16_f32 v146, v145, v145
    v_and_b32 v147, 0xffff0000, v146
    v_sub_f32 v145, v145, v147
    v_cvt_pk_bf16_f32 v145, v145, v145
    ds_write_b16 v158, v146
    ds_write_b16 v158, v145 offset:128
    s_waitcnt lgkmcnt(0)
    ds_read_b128 v[136:139], v159
    s_waitcnt lgkmcnt(0)
    v_mul_u32_u24_sdwa v104, v136, v12 dst_sel:DWORD dst_unused:UNUSED_PAD src0_sel:WORD_0 src1_sel:DWORD
    v_mul_u32_u24_sdwa v105, v136, v13 dst_sel:DWORD dst_unused:UNUSED_PAD src0_sel:WORD_0 src1_sel:DWORD
    v_mul_u32_u24_sdwa v106, v136, v14 dst_sel:DWORD dst_unused:UNUSED_PAD src0_sel:WORD_0 src1_sel:DWORD
    v_mul_u32_u24_sdwa v107, v136, v15 dst_sel:DWORD dst_unused:UNUSED_PAD src0_sel:WORD_0 src1_sel:DWORD
    v_mul_u32_u24_sdwa v108, v136, v12 dst_sel:DWORD dst_unused:UNUSED_PAD src0_sel:WORD_1 src1_sel:DWORD
    v_mul_u32_u24_sdwa v109, v136, v13 dst_sel:DWORD dst_unused:UNUSED_PAD src0_sel:WORD_1 src1_sel:DWORD
    v_mul_u32_u24_sdwa v110, v136, v14 dst_sel:DWORD dst_unused:UNUSED_PAD src0_sel:WORD_1 src1_sel:DWORD
    v_mul_u32_u24_sdwa v111, v136, v15 dst_sel:DWORD dst_unused:UNUSED_PAD src0_sel:WORD_1 src1_sel:DWORD
    v_mul_u32_u24_sdwa v112, v137, v12 dst_sel:DWORD dst_unused:UNUSED_PAD src0_sel:WORD_0 src1_sel:DWORD
    v_mul_u32_u24_sdwa v113, v137, v13 dst_sel:DWORD dst_unused:UNUSED_PAD src0_sel:WORD_0 src1_sel:DWORD
    v_mul_u32_u24_sdwa v114, v137, v14 dst_sel:DWORD dst_unused:UNUSED_PAD src0_sel:WORD_0 src1_sel:DWORD
    v_mul_u32_u24_sdwa v115, v137, v15 dst_sel:DWORD dst_unused:UNUSED_PAD src0_sel:WORD_0 src1_sel:DWORD
    v_mul_u32_u24_sdwa v116, v137, v12 dst_sel:DWORD dst_unused:UNUSED_PAD src0_sel:WORD_1 src1_sel:DWORD
    v_mul_u32_u24_sdwa v117, v137, v13 dst_sel:DWORD dst_unused:UNUSED_PAD src0_sel:WORD_1 src1_sel:DWORD
    v_mul_u32_u24_sdwa v118, v137, v14 dst_sel:DWORD dst_unused:UNUSED_PAD src0_sel:WORD_1 src1_sel:DWORD
    v_mul_u32_u24_sdwa v119, v137, v15 dst_sel:DWORD dst_unused:UNUSED_PAD src0_sel:WORD_1 src1_sel:DWORD
    v_mul_u32_u24_sdwa v120, v138, v12 dst_sel:DWORD dst_unused:UNUSED_PAD src0_sel:WORD_0 src1_sel:DWORD
    v_mul_u32_u24_sdwa v121, v138, v13 dst_sel:DWORD dst_unused:UNUSED_PAD src0_sel:WORD_0 src1_sel:DWORD
    v_mul_u32_u24_sdwa v122, v138, v14 dst_sel:DWORD dst_unused:UNUSED_PAD src0_sel:WORD_0 src1_sel:DWORD
    v_mul_u32_u24_sdwa v123, v138, v15 dst_sel:DWORD dst_unused:UNUSED_PAD src0_sel:WORD_0 src1_sel:DWORD
    v_mul_u32_u24_sdwa v124, v138, v12 dst_sel:DWORD dst_unused:UNUSED_PAD src0_sel:WORD_1 src1_sel:DWORD
    v_mul_u32_u24_sdwa v125, v138, v13 dst_sel:DWORD dst_unused:UNUSED_PAD src0_sel:WORD_1 src1_sel:DWORD
    v_mul_u32_u24_sdwa v126, v138, v14 dst_sel:DWORD dst_unused:UNUSED_PAD src0_sel:WORD_1 src1_sel:DWORD
    v_mul_u32_u24_sdwa v127, v138, v15 dst_sel:DWORD dst_unused:UNUSED_PAD src0_sel:WORD_1 src1_sel:DWORD
    v_mul_u32_u24_sdwa v128, v139, v12 dst_sel:DWORD dst_unused:UNUSED_PAD src0_sel:WORD_0 src1_sel:DWORD
    v_mul_u32_u24_sdwa v129, v139, v13 dst_sel:DWORD dst_unused:UNUSED_PAD src0_sel:WORD_0 src1_sel:DWORD
    v_mul_u32_u24_sdwa v130, v139, v14 dst_sel:DWORD dst_unused:UNUSED_PAD src0_sel:WORD_0 src1_sel:DWORD
    v_mul_u32_u24_sdwa v131, v139, v15 dst_sel:DWORD dst_unused:UNUSED_PAD src0_sel:WORD_0 src1_sel:DWORD
    v_mul_u32_u24_sdwa v132, v139, v12 dst_sel:DWORD dst_unused:UNUSED_PAD src0_sel:WORD_1 src1_sel:DWORD
    v_mul_u32_u24_sdwa v133, v139, v13 dst_sel:DWORD dst_unused:UNUSED_PAD src0_sel:WORD_1 src1_sel:DWORD
    v_mul_u32_u24_sdwa v134, v139, v14 dst_sel:DWORD dst_unused:UNUSED_PAD src0_sel:WORD_1 src1_sel:DWORD
    v_mul_u32_u24_sdwa v135, v139, v15 dst_sel:DWORD dst_unused:UNUSED_PAD src0_sel:WORD_1 src1_sel:DWORD
    s_add_u32 s3, s7, 0
    buffer_load_dwordx4 v[72:75], v65, s[32:35], s3 offen sc1
    s_add_u32 s3, s7, 256
    buffer_load_dwordx4 v[76:79], v65, s[32:35], s3 offen sc1
    s_add_u32 s3, s7, 512
    buffer_load_dwordx4 v[80:83], v65, s[32:35], s3 offen sc1
    s_add_u32 s3, s7, 768
    buffer_load_dwordx4 v[84:87], v65, s[32:35], s3 offen sc1
    s_add_u32 s3, s7, 1024
    buffer_load_dwordx4 v[88:91], v65, s[32:35], s3 offen sc1
    s_add_u32 s3, s7, 1280
    buffer_load_dwordx4 v[92:95], v65, s[32:35], s3 offen sc1
    s_add_u32 s3, s7, 1536
    buffer_load_dwordx4 v[96:99], v65, s[32:35], s3 offen sc1
    s_add_u32 s3, s7, 1792
    buffer_load_dwordx4 v[100:103], v65, s[32:35], s3 offen sc1
    v_add_f32_dpp v61, v61, v61 row_ror:8 row_mask:0xf bank_mask:0xf
    s_nop 1
    v_add_f32_dpp v61, v61, v61 row_ror:4 row_mask:0xf bank_mask:0xf
    s_nop 1
    v_add_f32_dpp v61, v61, v61 row_ror:2 row_mask:0xf bank_mask:0xf
    s_nop 1
    v_add_f32_dpp v61, v61, v61 row_ror:1 row_mask:0xf bank_mask:0xf
    v_mov_b32 v146, v61
    s_nop 1
    v_permlane16_swap_b32 v61, v146
    v_add_f32 v61, v61, v146
    v_mov_b32 v146, v61
    s_nop 1
    v_permlane32_swap_b32 v61, v146
    v_add_f32 v61, v61, v146
    v_rcp_f32 v60, v61
    s_nop 0
    v_mov_b32 v61, v60
L_W_comb:
    v_mov_b32 v144, -1
    s_waitcnt vmcnt(7)
    v_xor_b32 v72, v72, v68
    v_xor_b32 v73, v73, v69
    v_xor_b32 v74, v74, v70
    v_xor_b32 v75, v75, v71
    v_bitop3_b32 v144, v144, v72, v73 bitop3:0x80
    v_bitop3_b32 v144, v144, v74, v75 bitop3:0x80
    v_mfma_f32_16x16x32_bf16 v[140:143], v[104:107], v[72:75], 0
    s_waitcnt vmcnt(6)
    v_xor_b32 v76, v76, v68
    v_xor_b32 v77, v77, v69
    v_xor_b32 v78, v78, v70
    v_xor_b32 v79, v79, v71
    v_bitop3_b32 v144, v144, v76, v77 bitop3:0x80
    v_bitop3_b32 v144, v144, v78, v79 bitop3:0x80
    v_mfma_f32_16x16x32_bf16 v[140:143], v[108:111], v[76:79], v[140:143]
    s_waitcnt vmcnt(5)
    v_xor_b32 v80, v80, v68
    v_xor_b32 v81, v81, v69
    v_xor_b32 v82, v82, v70
    v_xor_b32 v83, v83, v71
    v_bitop3_b32 v144, v144, v80, v81 bitop3:0x80
    v_bitop3_b32 v144, v144, v82, v83 bitop3:0x80
    v_mfma_f32_16x16x32_bf16 v[140:143], v[112:115], v[80:83], v[140:143]
    s_waitcnt vmcnt(4)
    v_xor_b32 v84, v84, v68
    v_xor_b32 v85, v85, v69
    v_xor_b32 v86, v86, v70
    v_xor_b32 v87, v87, v71
    v_bitop3_b32 v144, v144, v84, v85 bitop3:0x80
    v_bitop3_b32 v144, v144, v86, v87 bitop3:0x80
    v_mfma_f32_16x16x32_bf16 v[140:143], v[116:119], v[84:87], v[140:143]
    s_waitcnt vmcnt(3)
    v_xor_b32 v88, v88, v68
    v_xor_b32 v89, v89, v69
    v_xor_b32 v90, v90, v70
    v_xor_b32 v91, v91, v71
    v_bitop3_b32 v144, v144, v88, v89 bitop3:0x80
    v_bitop3_b32 v144, v144, v90, v91 bitop3:0x80
    v_mfma_f32_16x16x32_bf16 v[140:143], v[120:123], v[88:91], v[140:143]
    s_waitcnt vmcnt(2)
    v_xor_b32 v92, v92, v68
    v_xor_b32 v93, v93, v69
    v_xor_b32 v94, v94, v70
    v_xor_b32 v95, v95, v71
    v_bitop3_b32 v144, v144, v92, v93 bitop3:0x80
    v_bitop3_b32 v144, v144, v94, v95 bitop3:0x80
    v_mfma_f32_16x16x32_bf16 v[140:143], v[124:127], v[92:95], v[140:143]
    s_waitcnt vmcnt(1)
    v_xor_b32 v96, v96, v68
    v_xor_b32 v97, v97, v69
    v_xor_b32 v98, v98, v70
    v_xor_b32 v99, v99, v71
    v_bitop3_b32 v144, v144, v96, v97 bitop3:0x80
    v_bitop3_b32 v144, v144, v98, v99 bitop3:0x80
    v_mfma_f32_16x16x32_bf16 v[140:143], v[128:131], v[96:99], v[140:143]
    s_waitcnt vmcnt(0)
    v_xor_b32 v100, v100, v68
    v_xor_b32 v101, v101, v69
    v_xor_b32 v102, v102, v70
    v_xor_b32 v103, v103, v71
    v_bitop3_b32 v144, v144, v100, v101 bitop3:0x80
    v_bitop3_b32 v144, v144, v102, v103 bitop3:0x80
    v_mfma_f32_16x16x32_bf16 v[140:143], v[132:135], v[100:103], v[140:143]
    v_and_b32 v144, 0x10001, v144
    v_cmp_ne_u32 vcc, 0x10001, v144
    s_add_u32 s62, s62, 1
    s_cbranch_vccnz L_W_oagain
L_W_cok:
    v_and_b32 v7, 1, v3
    v_cmp_eq_u32 vcc, 1, v7
    s_nop 1
    v_pk_mul_f32 v[140:141], v[140:141], v[60:61]
    v_pk_mul_f32 v[142:143], v[142:143], v[60:61]
    v_cvt_pk_bf16_f32 v136, v140, v141
    v_cvt_pk_bf16_f32 v137, v142, v143
    ds_write_b64 v148, v[136:137]
    s_waitcnt lgkmcnt(0)
    s_barrier
    ds_read_b128 v[168:171], v149 offset:0
    ds_read_b128 v[172:175], v149 offset:64
    ds_read_b128 v[176:179], v149 offset:128
    ds_read_b128 v[180:183], v149 offset:192
    s_mov_b64 exec, 1
    buffer_store_dword v8, v5, s[32:35], s91 offen sc1
    s_mov_b64 exec, -1
    s_waitcnt lgkmcnt(3)
    v_mfma_f32_16x16x32_bf16 v[216:219], v[168:171], a[128:131], 0
    v_mfma_f32_16x16x32_bf16 v[220:223], v[168:171], a[144:147], 0
    s_waitcnt lgkmcnt(2)
    v_mfma_f32_16x16x32_bf16 v[216:219], v[172:175], a[132:135], v[216:219]
    v_mfma_f32_16x16x32_bf16 v[220:223], v[172:175], a[148:151], v[220:223]
    s_waitcnt lgkmcnt(1)
    v_mfma_f32_16x16x32_bf16 v[216:219], v[176:179], a[136:139], v[216:219]
    v_mfma_f32_16x16x32_bf16 v[220:223], v[176:179], a[152:155], v[220:223]
    s_waitcnt lgkmcnt(0)
    v_mfma_f32_16x16x32_bf16 v[216:219], v[180:183], a[140:143], v[216:219]
    v_mfma_f32_16x16x32_bf16 v[220:223], v[180:183], a[156:159], v[220:223]
    s_nop 6
    v_pk_add_f32 v[216:217], v[216:217], v[218:219]
    v_pk_add_f32 v[220:221], v[220:221], v[222:223]
    v_add_f32 v216, v216, v217
    v_add_f32 v220, v220, v221
    v_cndmask_b32 v6, v216, v220, vcc
    v_cvt_pk_bf16_f32 v6, v6, v6
    ds_write_b16 v150, v6
    s_waitcnt lgkmcnt(0)
    s_barrier
    ds_read_b128 v[104:107], v192
    ds_read_b128 v[108:111], v193
    ds_read_b128 v[112:115], v194
    ds_read_b128 v[116:119], v195
    ds_read_b128 v[120:123], v196
    ds_read_b128 v[124:127], v197
    ds_read_b128 v[128:131], v198
    ds_read_b128 v[132:135], v199
    s_waitcnt lgkmcnt(7)
    v_smfmac_f32_16x16x64_bf16 v[184:187], v[104:107], a[0:7], v154
    v_smfmac_f32_16x16x64_bf16 v[188:191], v[104:107], a[16:23], v154
    s_waitcnt lgkmcnt(6)
    v_smfmac_f32_16x16x64_bf16 v[184:187], v[108:111], a[8:15], v154
    v_smfmac_f32_16x16x64_bf16 v[188:191], v[108:111], a[24:31], v154
    s_waitcnt lgkmcnt(5)
    v_smfmac_f32_16x16x64_bf16 v[184:187], v[112:115], a[32:39], v154
    v_smfmac_f32_16x16x64_bf16 v[188:191], v[112:115], a[48:55], v154
    s_waitcnt lgkmcnt(4)
    v_smfmac_f32_16x16x64_bf16 v[184:187], v[116:119], a[40:47], v154
    v_smfmac_f32_16x16x64_bf16 v[188:191], v[116:119], a[56:63], v154
    s_waitcnt lgkmcnt(3)
    v_smfmac_f32_16x16x64_bf16 v[184:187], v[120:123], a[64:71], v154
    v_smfmac_f32_16x16x64_bf16 v[188:191], v[120:123], a[80:87], v154
    s_waitcnt lgkmcnt(2)
    v_smfmac_f32_16x16x64_bf16 v[184:187], v[124:127], a[72:79], v154
    v_smfmac_f32_16x16x64_bf16 v[188:191], v[124:127], a[88:95], v154
    s_waitcnt lgkmcnt(1)
    v_smfmac_f32_16x16x64_bf16 v[184:187], v[128:131], a[96:103], v154
    v_smfmac_f32_16x16x64_bf16 v[188:191], v[128:131], a[112:119], v154
    s_waitcnt lgkmcnt(0)
    v_smfmac_f32_16x16x64_bf16 v[184:187], v[132:135], a[104:111], v154
    v_smfmac_f32_16x16x64_bf16 v[188:191], v[132:135], a[120:127], v154
    s_nop 6
    v_pk_add_f32 v[184:185], v[184:185], v[186:187]
    v_pk_add_f32 v[188:189], v[188:189], v[190:191]
    v_and_or_b32 v216, v184, v157, s58
    v_and_or_b32 v217, v185, v157, s59
    v_and_or_b32 v218, v188, v157, s60
    v_and_or_b32 v219, v189, v157, s61
    buffer_store_dwordx4 v[216:219], v156, s[32:35], s88 offen sc1
    s_mov_b32 s62, 0
    s_waitcnt vmcnt(0)
L_W_fin:
    buffer_load_dwordx4 v[72:75], v160, s[32:35], s89 offen sc1
    v_mov_b32 v76, s58
    v_mov_b32 v77, s59
    v_mov_b32 v78, s60
    v_mov_b32 v79, s61
    s_and_saveexec_b64 s[100:101], s[16:17]
    buffer_load_dwordx4 v[76:79], v160, s[32:35], s90 offen sc1
    s_mov_b64 exec, s[100:101]
    v_mov_b32 v144, 0
    s_add_u32 s62, s62, 1
    s_waitcnt vmcnt(0)
    v_xor_b32 v72, s58, v72
    v_xor_b32 v73, s59, v73
    v_xor_b32 v74, s60, v74
    v_xor_b32 v75, s61, v75
    v_or3_b32 v144, v72, v73, v74
    s_waitcnt vmcnt(0)
    v_xor_b32 v76, s58, v76
    v_xor_b32 v77, s59, v77
    v_xor_b32 v78, s60, v78
    v_xor_b32 v79, s61, v79
    v_or3_b32 v6, v75, v76, v77
    v_or3_b32 v144, v144, v78, v79
    v_bitop3_b32 v144, v144, v6, v157 bitop3:0x54
    v_cmp_ne_u32 vcc, 0, v144
    s_cbranch_vccnz L_W_fagain
L_W_fok:
    s_mov_b64 exec, -1
    v_permlane16_swap_b32 v72, v76
    v_permlane16_swap_b32 v73, v77
    v_permlane16_swap_b32 v74, v78
    v_permlane16_swap_b32 v75, v79
    v_add_f32 v72, v72, v76
    v_add_f32 v73, v73, v77
    v_add_f32 v74, v74, v78
    v_add_f32 v75, v75, v79
    s_nop 0
    v_permlane32_swap_b32 v72, v74
    v_permlane32_swap_b32 v73, v75
    v_add_f32 v72, v72, v74
    v_add_f32 v73, v73, v75
    s_nop 0
    v_add_f32_dpp v72, v72, v72 row_ror:8 row_mask:0xf bank_mask:0xf
    v_add_f32_dpp v73, v73, v73 row_ror:8 row_mask:0xf bank_mask:0xf
    s_nop 0
    v_add_f32_dpp v72, v72, v72 row_ror:4 row_mask:0xf bank_mask:0xf
    v_add_f32_dpp v73, v73, v73 row_ror:4 row_mask:0xf bank_mask:0xf
    s_nop 0
    v_add_f32_dpp v72, v72, v72 row_ror:2 row_mask:0xf bank_mask:0xf
    v_add_f32_dpp v73, v73, v73 row_ror:2 row_mask:0xf bank_mask:0xf
    s_mov_b32 exec_lo, 0x00030003
    s_mov_b32 exec_hi, 0x00030003
    ds_write2_b32 v163, v72, v73 offset0:0 offset1:8
    s_mov_b64 exec, -1
    s_cmp_lg_u32 s30, 0
    s_waitcnt lgkmcnt(0)
    s_barrier
    s_cbranch_scc1 L_W_last
    ds_read_b128 v[104:107], v164
    ds_read_b128 v[108:111], v164 offset:16
    ds_read_b128 v[112:115], v164 offset:128
    ds_read_b128 v[116:119], v164 offset:144
    v_lshlrev_b32 v72, 16, v162
    v_and_b32 v73, 0xffff0000, v162
    s_mov_b64 exec, 15
    s_waitcnt lgkmcnt(3)
    v_pk_add_f32 v[104:105], v[104:105], v[106:107]
    v_add_f32 v104, v104, v105
    s_waitcnt lgkmcnt(2)
    v_pk_add_f32 v[108:109], v[108:109], v[110:111]
    v_add_f32 v108, v108, v109
    s_waitcnt lgkmcnt(1)
    v_pk_add_f32 v[112:113], v[112:113], v[114:115]
    v_add_f32 v112, v112, v113
    s_waitcnt lgkmcnt(0)
    v_pk_add_f32 v[116:117], v[116:117], v[118:119]
    v_add_f32 v116, v116, v117
    v_cvt_pk_bf16_f32 v76, v104, v108
    v_cvt_pk_bf16_f32 v77, v112, v116
    v_lshlrev_b32 v74, 16, v76
    v_and_b32 v75, 0xffff0000, v76
    v_pk_add_f32 v[72:73], v[72:73], v[74:75]
    v_lshlrev_b32 v74, 16, v77
    v_cvt_pk_bf16_f32 v76, v72, v73
    v_and_b32 v75, 0xffff0000, v77
    v_lshlrev_b32 v72, 16, v76
    v_and_b32 v73, 0xffff0000, v76
    v_pk_add_f32 v[72:73], v[72:73], v[74:75]
    v_cvt_pk_bf16_f32 v76, v72, v73
    global_store_dword v161, v76, s[24:25]
L_W_last:
L_exit:
    s_endpgm
L_W_oagain:
    s_cmp_lt_u32 s62, 30000
    s_cbranch_scc0 L_W_cok
    s_add_u32 s3, s7, 0
    buffer_load_dwordx4 v[72:75], v65, s[32:35], s3 offen sc1
    s_add_u32 s3, s7, 256
    buffer_load_dwordx4 v[76:79], v65, s[32:35], s3 offen sc1
    s_add_u32 s3, s7, 512
    buffer_load_dwordx4 v[80:83], v65, s[32:35], s3 offen sc1
    s_add_u32 s3, s7, 768
    buffer_load_dwordx4 v[84:87], v65, s[32:35], s3 offen sc1
    s_add_u32 s3, s7, 1024
    buffer_load_dwordx4 v[88:91], v65, s[32:35], s3 offen sc1
    s_add_u32 s3, s7, 1280
    buffer_load_dwordx4 v[92:95], v65, s[32:35], s3 offen sc1
    s_add_u32 s3, s7, 1536
    buffer_load_dwordx4 v[96:99], v65, s[32:35], s3 offen sc1
    s_add_u32 s3, s7, 1792
    buffer_load_dwordx4 v[100:103], v65, s[32:35], s3 offen sc1
    s_branch L_W_comb
L_W_fagain:
    s_cmp_lt_u32 s62, 120000
    s_cbranch_scc0 L_W_fok
    s_mov_b64 exec, vcc
    s_branch L_W_fin
L_A:
    v_lshrrev_b32 v6, 5, v1
    v_and_b32 v7, 31, v1
    v_lshlrev_b32 v6, 10, v6
    v_lshl_add_u32 v6, v7, 4, v6
    s_bfe_u32 s31, s52, 0x10002
    s_lshl_b32 s31, s31, 9
    s_and_b32 s3, s30, 1
    s_lshl_b32 s3, s3, 3
    s_or_b32 s31, s31, s3
    v_xor_b32 v6, s31, v6
    v_xor_b32 v7, 8, v6
    v_xor_b32 v166, 0x200, v6
    v_xor_b32 v167, 0x208, v6
    s_mov_b32 s38, 0x1000000
    s_waitcnt lgkmcnt(0)
    s_mov_b32 s32, s28
    s_mov_b32 s33, s29
    buffer_load_dword v8, v5, s[32:35], 0 offen sc1
    global_load_dwordx2 v[160:161], v6, s[4:5]
    global_load_dwordx2 v[162:163], v7, s[4:5]
    global_load_dwordx2 v[164:165], v166, s[4:5]
    global_load_dwordx2 v[166:167], v167, s[4:5]
    s_mov_b32 s36, s6
    s_mov_b32 s37, s7
    s_mov_b32 s40, s10
    s_mov_b32 s41, s11
    s_mov_b32 s42, 4194304
    s_mov_b32 s43, 0x20000
    s_lshl_b32 s25, s30, 15
    s_lshl_b32 s88, s52, 17
    s_add_u32 s88, s88, s25
    s_mov_b32 s16, 3932342336
    s_mov_b32 s17, 4218673489
    s_mov_b32 s24, 0x40000
    s_lshl_b32 s90, s30, 13
    s_add_u32 s90, s90, 131072
    s_mov_b32 m0, s90
    v_lshlrev_b32 v7, 13, v3
    v_lshl_add_u32 v7, v2, 4, v7
    v_lshlrev_b32 v4, 4, v1
    s_mov_b32 s3, 0
    s_waitcnt vmcnt(0)
L_A_u:
    buffer_load_dwordx4 v7, s[40:43], s98 offen  lds
    s_addk_i32 m0, 0x400
    s_add_u32 s98, s98, 0x8000
    s_add_u32 s3, s3, 1
    s_cmp_lt_u32 s3, 8
    s_cbranch_scc1 L_A_u
    s_add_u32 m0, s25, 0
L_A_c1:
    s_bfe_u64 s[100:101], s[16:17], s24
    s_add_u32 s24, s24, 4
    v_xor_b32 v6, s100, v1
    v_lshlrev_b32 v6, 4, v6
    buffer_load_dwordx4 v6, s[36:39], s88 offen nt lds
    s_addk_i32 m0, 0x400
    s_addk_i32 s88, 0x400
    s_cmp_lt_u32 s24, 262152
    s_cbranch_scc1 L_A_c1
    v_lshlrev_b32 v168, 16, v160
    v_and_b32 v169, 0xffff0000, v160
    v_lshlrev_b32 v170, 16, v161
    v_and_b32 v171, 0xffff0000, v161
    v_lshlrev_b32 v172, 16, v162
    v_and_b32 v173, 0xffff0000, v162
    v_lshlrev_b32 v174, 16, v163
    v_and_b32 v175, 0xffff0000, v163
    v_lshlrev_b32 v176, 16, v164
    v_and_b32 v177, 0xffff0000, v164
    v_lshlrev_b32 v178, 16, v165
    v_and_b32 v179, 0xffff0000, v165
    v_lshlrev_b32 v180, 16, v166
    v_and_b32 v181, 0xffff0000, v166
    v_lshlrev_b32 v182, 16, v167
    v_and_b32 v183, 0xffff0000, v167
    v_pk_add_f32 v[184:185], v[168:169], v[170:171]
    v_pk_add_f32 v[186:187], v[172:173], v[174:175]
    v_pk_add_f32 v[184:185], v[184:185], v[176:177]
    v_pk_add_f32 v[186:187], v[186:187], v[178:179]
    v_pk_add_f32 v[184:185], v[184:185], v[180:181]
    v_pk_add_f32 v[186:187], v[186:187], v[182:183]
    v_pk_add_f32 v[184:185], v[184:185], v[186:187]
    v_add_f32 v184, v184, v185
    s_nop 1
    v_add_f32_dpp v184, v184, v184 row_ror:8 row_mask:0xf bank_mask:0xf
    s_nop 1
    v_add_f32_dpp v184, v184, v184 row_ror:4 row_mask:0xf bank_mask:0xf
    s_nop 1
    v_add_f32_dpp v184, v184, v184 row_ror:2 row_mask:0xf bank_mask:0xf
    s_nop 1
    v_add_f32_dpp v184, v184, v184 row_ror:1 row_mask:0xf bank_mask:0xf
    v_mov_b32 v185, v184
    s_nop 1
    v_permlane16_swap_b32 v184, v185
    v_add_f32 v184, v184, v185
    v_mul_f32 v184, 0xbb000000, v184
    v_mov_b32 v185, v184
    v_pk_add_f32 v[186:187], v[168:169], v[184:185]
    v_pk_mul_f32 v[188:189], v[186:187], v[186:187]
    v_pk_add_f32 v[186:187], v[170:171], v[184:185]
    v_pk_fma_f32 v[188:189], v[186:187], v[186:187], v[188:189]
    v_pk_add_f32 v[186:187], v[172:173], v[184:185]
    v_pk_fma_f32 v[188:189], v[186:187], v[186:187], v[188:189]
    v_pk_add_f32 v[186:187], v[174:175], v[184:185]
    v_pk_fma_f32 v[188:189], v[186:187], v[186:187], v[188:189]
    v_pk_add_f32 v[186:187], v[176:177], v[184:185]
    v_pk_fma_f32 v[188:189], v[186:187], v[186:187], v[188:189]
    v_pk_add_f32 v[186:187], v[178:179], v[184:185]
    v_pk_fma_f32 v[188:189], v[186:187], v[186:187], v[188:189]
    v_pk_add_f32 v[186:187], v[180:181], v[184:185]
    v_pk_fma_f32 v[188:189], v[186:187], v[186:187], v[188:189]
    v_pk_add_f32 v[186:187], v[182:183], v[184:185]
    v_pk_fma_f32 v[188:189], v[186:187], v[186:187], v[188:189]
    v_add_f32 v188, v188, v189
    v_cvt_pk_bf16_f32 v184, v184, v184
    v_and_b32 v184, 0xffff0000, v184
    v_mov_b32 v185, v184
    v_add_f32_dpp v188, v188, v188 row_ror:8 row_mask:0xf bank_mask:0xf
    s_nop 1
    v_add_f32_dpp v188, v188, v188 row_ror:4 row_mask:0xf bank_mask:0xf
    s_nop 1
    v_add_f32_dpp v188, v188, v188 row_ror:2 row_mask:0xf bank_mask:0xf
    s_nop 1
    v_add_f32_dpp v188, v188, v188 row_ror:1 row_mask:0xf bank_mask:0xf
    v_mov_b32 v189, v188
    s_nop 1
    v_permlane16_swap_b32 v188, v189
    v_add_f32 v188, v188, v189
    v_mul_f32 v188, 0x3b000000, v188
    v_cvt_pk_bf16_f32 v188, v188, v188
    v_and_b32 v188, 0xffff0000, v188
    v_add_f32 v188, 0x3727c5ac, v188
    v_cvt_pk_bf16_f32 v188, v188, v188
    v_and_b32 v188, 0xffff0000, v188
    v_sqrt_f32 v188, v188
    v_pk_add_f32 v[168:169], v[168:169], v[184:185]
    v_pk_add_f32 v[170:171], v[170:171], v[184:185]
    v_pk_add_f32 v[172:173], v[172:173], v[184:185]
    v_pk_add_f32 v[174:175], v[174:175], v[184:185]
    v_pk_add_f32 v[176:177], v[176:177], v[184:185]
    v_pk_add_f32 v[178:179], v[178:179], v[184:185]
    v_pk_add_f32 v[180:181], v[180:181], v[184:185]
    v_pk_add_f32 v[182:183], v[182:183], v[184:185]
    v_cvt_pk_bf16_f32 v188, v188, v188
    v_and_b32 v188, 0xffff0000, v188
    v_rcp_f32 v188, v188
    v_cvt_pk_bf16_f32 v160, v168, v169
    v_cvt_pk_bf16_f32 v161, v170, v171
    v_cvt_pk_bf16_f32 v162, v172, v173
    v_cvt_pk_bf16_f32 v163, v174, v175
    v_cvt_pk_bf16_f32 v164, v176, v177
    v_cvt_pk_bf16_f32 v165, v178, v179
    v_cvt_pk_bf16_f32 v166, v180, v181
    v_cvt_pk_bf16_f32 v167, v182, v183
    v_mov_b32 v189, v188
    v_lshlrev_b32 v168, 16, v160
    v_and_b32 v169, 0xffff0000, v160
    v_lshlrev_b32 v170, 16, v161
    v_and_b32 v171, 0xffff0000, v161
    v_lshlrev_b32 v172, 16, v162
    v_and_b32 v173, 0xffff0000, v162
    v_lshlrev_b32 v174, 16, v163
    v_and_b32 v175, 0xffff0000, v163
    v_lshlrev_b32 v176, 16, v164
    v_and_b32 v177, 0xffff0000, v164
    v_lshlrev_b32 v178, 16, v165
    v_and_b32 v179, 0xffff0000, v165
    v_lshlrev_b32 v180, 16, v166
    v_and_b32 v181, 0xffff0000, v166
    v_lshlrev_b32 v182, 16, v167
    v_and_b32 v183, 0xffff0000, v167
    v_pk_mul_f32 v[168:169], v[168:169], v[188:189]
    v_pk_mul_f32 v[170:171], v[170:171], v[188:189]
    v_pk_mul_f32 v[172:173], v[172:173], v[188:189]
    v_pk_mul_f32 v[174:175], v[174:175], v[188:189]
    v_pk_mul_f32 v[176:177], v[176:177], v[188:189]
    v_pk_mul_f32 v[178:179], v[178:179], v[188:189]
    v_pk_mul_f32 v[180:181], v[180:181], v[188:189]
    v_pk_mul_f32 v[182:183], v[182:183], v[188:189]
    v_cvt_pk_bf16_f32 v160, v168, v169
    v_cvt_pk_bf16_f32 v161, v170, v171
    v_cvt_pk_bf16_f32 v162, v172, v173
    v_cvt_pk_bf16_f32 v163, v174, v175
    v_cvt_pk_bf16_f32 v164, v176, v177
    v_cvt_pk_bf16_f32 v165, v178, v179
    v_cvt_pk_bf16_f32 v166, v180, v181
    v_cvt_pk_bf16_f32 v167, v182, v183
    v_and_b32 v6, 1, v1
    v_lshlrev_b32 v6, 4, v6
    v_lshlrev_b32 v6, v6, 1
    v_bfe_u32 v7, v1, 1, 2
    v_cmp_eq_u32 vcc, 0, v7
    s_nop 1
    v_cndmask_b32 v192, 0, v6, vcc
    v_cmp_eq_u32 vcc, 1, v7
    s_nop 1
    v_cndmask_b32 v193, 0, v6, vcc
    v_cmp_eq_u32 vcc, 2, v7
    s_nop 1
    v_cndmask_b32 v194, 0, v6, vcc
    v_cmp_eq_u32 vcc, 3, v7
    s_nop 1
    v_cndmask_b32 v195, 0, v6, vcc
    s_and_b32 s31, s52, 3
    s_lshl_b32 s31, s31, 3
    s_lshr_b32 s3, s30, 1
    s_add_u32 s31, s31, s3
    v_lshl_add_u32 v6, v3, 1, s31
    v_bfe_u32 v7, v1, 3, 1
    v_lshl_add_u32 v6, v7, 5, v6
    v_lshlrev_b32 v6, 2, v6
    ds_bpermute_b32 v184, v6, v160
    ds_bpermute_b32 v185, v6, v161
    v_mul_u32_u24 v28, 57344, v3
    v_lshl_add_u32 v28, v2, 4, v28
    s_and_b32 s31, s52, 7
    s_lshl_b32 s31, s31, 4
    s_add_u32 s31, s31, s30
    s_mul_i32 s94, s31, 14336
    s_lshr_b32 s31, s52, 3
    s_lshl_b32 s31, s31, 8
    s_add_u32 s94, s94, s31
    s_cmp_lt_u32 s52, 112
    s_cselect_b32 s31, 1835008, 0
    s_mov_b32 s40, s18
    s_mov_b32 s41, s19
    s_mov_b32 s42, s31
    s_mov_b32 s43, 0x20000
    s_mov_b32 s44, s20
    s_mov_b32 s45, s21
    s_mov_b32 s46, s31
    s_mov_b32 s47, 0x20000
    s_mov_b32 s48, s22
    s_mov_b32 s49, s23
    s_mov_b32 s50, s31
    s_mov_b32 s51, 0x20000
    s_waitcnt lgkmcnt(0)
    v_mul_u32_u24_sdwa v12, v184, v192 dst_sel:DWORD dst_unused:UNUSED_PAD src0_sel:WORD_0 src1_sel:DWORD
    v_mul_u32_u24_sdwa v13, v184, v193 dst_sel:DWORD dst_unused:UNUSED_PAD src0_sel:WORD_0 src1_sel:DWORD
    v_mul_u32_u24_sdwa v14, v184, v194 dst_sel:DWORD dst_unused:UNUSED_PAD src0_sel:WORD_0 src1_sel:DWORD
    v_mul_u32_u24_sdwa v15, v184, v195 dst_sel:DWORD dst_unused:UNUSED_PAD src0_sel:WORD_0 src1_sel:DWORD
    v_mul_u32_u24_sdwa v16, v184, v192 dst_sel:DWORD dst_unused:UNUSED_PAD src0_sel:WORD_1 src1_sel:DWORD
    v_mul_u32_u24_sdwa v17, v184, v193 dst_sel:DWORD dst_unused:UNUSED_PAD src0_sel:WORD_1 src1_sel:DWORD
    v_mul_u32_u24_sdwa v18, v184, v194 dst_sel:DWORD dst_unused:UNUSED_PAD src0_sel:WORD_1 src1_sel:DWORD
    v_mul_u32_u24_sdwa v19, v184, v195 dst_sel:DWORD dst_unused:UNUSED_PAD src0_sel:WORD_1 src1_sel:DWORD
    v_mul_u32_u24_sdwa v20, v185, v192 dst_sel:DWORD dst_unused:UNUSED_PAD src0_sel:WORD_0 src1_sel:DWORD
    v_mul_u32_u24_sdwa v21, v185, v193 dst_sel:DWORD dst_unused:UNUSED_PAD src0_sel:WORD_0 src1_sel:DWORD
    v_mul_u32_u24_sdwa v22, v185, v194 dst_sel:DWORD dst_unused:UNUSED_PAD src0_sel:WORD_0 src1_sel:DWORD
    v_mul_u32_u24_sdwa v23, v185, v195 dst_sel:DWORD dst_unused:UNUSED_PAD src0_sel:WORD_0 src1_sel:DWORD
    v_mul_u32_u24_sdwa v24, v185, v192 dst_sel:DWORD dst_unused:UNUSED_PAD src0_sel:WORD_1 src1_sel:DWORD
    v_mul_u32_u24_sdwa v25, v185, v193 dst_sel:DWORD dst_unused:UNUSED_PAD src0_sel:WORD_1 src1_sel:DWORD
    v_mul_u32_u24_sdwa v26, v185, v194 dst_sel:DWORD dst_unused:UNUSED_PAD src0_sel:WORD_1 src1_sel:DWORD
    v_mul_u32_u24_sdwa v27, v185, v195 dst_sel:DWORD dst_unused:UNUSED_PAD src0_sel:WORD_1 src1_sel:DWORD
L_A_c2:
    s_bfe_u64 s[100:101], s[16:17], s24
    s_add_u32 s24, s24, 4
    v_xor_b32 v6, s100, v1
    v_lshlrev_b32 v6, 4, v6
    buffer_load_dwordx4 v6, s[36:39], s88 offen nt lds
    s_addk_i32 m0, 0x400
    s_addk_i32 s88, 0x400
    s_cmp_lt_u32 s24, 262160
    s_cbranch_scc1 L_A_c2
    v_and_b32 v89, 31, v1
    v_and_b32 v6, 3, v1
    v_lshlrev_b32 v6, 2, v6
    v_bfe_u32 v7, v1, 2, 1
    v_lshl_or_b32 v6, v7, 1, v6
    v_bfe_u32 v7, v1, 3, 1
    v_or_b32 v6, v6, v7
    v_lshrrev_b32 v7, 5, v1
    v_xor_b32 v6, v6, v7
    v_lshlrev_b32 v6, 4, v6
    v_lshlrev_b32 v30, 10, v89
    v_add_u32 v30, s25, v30
    v_lshlrev_b32 v38, 8, v89
    v_add_u32 v38, 131072, v38
    v_xor_b32 v7, 224, v6
    v_add_u32 v37, v30, v7
    v_add_u32 v45, v38, v7
    v_xor_b32 v7, 192, v6
    v_add_u32 v36, v30, v7
    v_add_u32 v44, v38, v7
    v_xor_b32 v7, 160, v6
    v_add_u32 v35, v30, v7
    v_add_u32 v43, v38, v7
    v_xor_b32 v7, 128, v6
    v_add_u32 v34, v30, v7
    v_add_u32 v42, v38, v7
    v_xor_b32 v7, 96, v6
    v_add_u32 v33, v30, v7
    v_add_u32 v41, v38, v7
    v_xor_b32 v7, 64, v6
    v_add_u32 v32, v30, v7
    v_add_u32 v40, v38, v7
    v_xor_b32 v7, 32, v6
    v_add_u32 v31, v30, v7
    v_add_u32 v39, v38, v7
    v_xor_b32 v7, 0, v6
    v_add_u32 v30, v30, v7
    v_add_u32 v38, v38, v7
    v_lshrrev_b32 v7, 5, v1
    v_lshlrev_b32 v85, 5, v89
    v_lshlrev_b32 v91, 9, v89
    v_lshl_add_u32 v7, v7, 2, v85
    v_add_u32 v85, 131072, v85
    s_lshl_b32 s97, s30, 3
    s_add_u32 s31, s97, 131072
    v_add_u32 v86, s31, v7
    v_bfe_u32 v6, v1, 4, 1
    v_lshlrev_b32 v6, 10, v6
    v_lshrrev_b32 v7, 5, v1
    v_lshl_or_b32 v6, v7, 8, v6
    v_lshl_or_b32 v6, v2, 4, v6
    s_lshl_b32 s31, s30, 11
    s_add_u32 s31, s31, 139264
    v_add_u32 v87, s31, v6
    v_add_u32 v90, 139264, v4
    v_lshrrev_b32 v6, 5, v1
    v_lshlrev_b32 v6, 4, v6
    v_bfe_u32 v7, v1, 4, 1
    v_lshl_or_b32 v6, v7, 2, v6
    v_bfe_u32 v47, v1, 2, 2
    v_or_b32 v6, v6, v47
    v_lshlrev_b32 v6, 10, v6
    v_and_b32 v48, 1, v1
    v_lshl_or_b32 v6, v48, 3, v6
    s_lshl_b32 s31, s30, 8
    v_add_u32 v6, s31, v6
    v_lshlrev_b32 v47, 2, v47
    v_lshl_or_b32 v47, v7, 1, v47
    v_bfe_u32 v48, v1, 1, 1
    v_xor_b32 v7, v47, v48
    v_lshlrev_b32 v7, 4, v7
    v_xor_b32 v46, 0, v7
    v_add_u32 v46, v46, v6
    v_add_u32 v62, 0x10000, v46
    v_xor_b32 v47, 16, v7
    v_add_u32 v47, v47, v6
    v_add_u32 v47, 8192, v47
    v_add_u32 v63, 0x10000, v47
    v_xor_b32 v48, 32, v7
    v_add_u32 v48, v48, v6
    v_add_u32 v64, 0x10000, v48
    v_xor_b32 v49, 48, v7
    v_add_u32 v49, v49, v6
    v_add_u32 v49, 8192, v49
    v_add_u32 v65, 0x10000, v49
    v_xor_b32 v50, 64, v7
    v_add_u32 v50, v50, v6
    v_add_u32 v66, 0x10000, v50
    v_xor_b32 v51, 80, v7
    v_add_u32 v51, v51, v6
    v_add_u32 v51, 8192, v51
    v_add_u32 v67, 0x10000, v51
    v_xor_b32 v52, 96, v7
    v_add_u32 v52, v52, v6
    v_add_u32 v68, 0x10000, v52
    v_xor_b32 v53, 112, v7
    v_add_u32 v53, v53, v6
    v_add_u32 v53, 8192, v53
    v_add_u32 v69, 0x10000, v53
    v_xor_b32 v54, 128, v7
    v_add_u32 v54, v54, v6
    v_add_u32 v70, 0x10000, v54
    v_xor_b32 v55, 144, v7
    v_add_u32 v55, v55, v6
    v_add_u32 v55, 8192, v55
    v_add_u32 v71, 0x10000, v55
    v_xor_b32 v56, 160, v7
    v_add_u32 v56, v56, v6
    v_add_u32 v72, 0x10000, v56
    v_xor_b32 v57, 176, v7
    v_add_u32 v57, v57, v6
    v_add_u32 v57, 8192, v57
    v_add_u32 v73, 0x10000, v57
    v_xor_b32 v58, 192, v7
    v_add_u32 v58, v58, v6
    v_add_u32 v74, 0x10000, v58
    v_xor_b32 v59, 208, v7
    v_add_u32 v59, v59, v6
    v_add_u32 v59, 8192, v59
    v_add_u32 v75, 0x10000, v59
    v_xor_b32 v60, 224, v7
    v_add_u32 v60, v60, v6
    v_add_u32 v76, 0x10000, v60
    v_xor_b32 v61, 240, v7
    v_add_u32 v61, v61, v6
    v_add_u32 v61, 8192, v61
    v_add_u32 v77, 0x10000, v61
    v_lshlrev_b32 v6, 2, v3
    v_xor_b32 v6, v6, v2
    v_lshlrev_b32 v6, 4, v6
    v_lshl_or_b32 v78, v3, 8, v6
    s_mov_b32 s31, 528384
    v_mul_lo_u32 v88, v3, s31
    v_lshl_add_u32 v88, v2, 4, v88
    v_mov_b32 v84, 0xfffefffe
    s_lshr_b32 s55, s52, 6
    s_lshl_b32 s89, s55, 15
    s_add_u32 s89, s89, s90
    s_add_u32 s89, s89, 4294840320
    s_lshl_b32 s91, s30, 7
    s_lshl_b32 s92, s55, 6
    s_add_u32 s92, s92, s91
    s_add_u32 s92, s92, 167936
    s_add_u32 s91, s91, 151552
    s_lshl_b32 s93, s52, 7
    s_add_u32 s93, s93, 135168
    s_cmp_eq_u32 s30, 1
    s_cselect_b32 s93, s93, 6291456
    s_mul_i32 s95, s52, 256
    s_mul_i32 s31, s30, 33024
    s_add_u32 s95, s95, s31
    s_add_u32 s95, s95, 524288
    s_lshl_b32 s96, s52, 9
    s_add_u32 s96, s96, 69632
    s_cmp_eq_u32 s30, 1
    s_cselect_b64 s[8:9], -1, 0
    s_cmp_eq_u32 s30, 2
    s_cselect_b64 s[12:13], -1, 0
    s_cmp_eq_u32 s30, 3
    s_cselect_b64 s[14:15], -1, 0
    s_mov_b32 s62, 0
    s_mov_b32 s22, 0
    v_readfirstlane_b32 s56, v8
    s_mov_b32 s63, 0x07060302
    s_mul_i32 s57, s56, 0x9E3779B1
    s_add_u32 s57, s57, 0x7F4A7C15
    s_mul_i32 s31, s56, 167
    s_add_u32 s58, s31, 0
    s_and_b32 s58, s58, 0xff
    s_add_u32 s59, s31, 85
    s_and_b32 s59, s59, 0xff
    s_add_u32 s60, s31, 163
    s_and_b32 s60, s60, 0xff
    s_add_u32 s61, s31, 60
    s_and_b32 s61, s61, 0xff
    s_add_u32 s23, s95, 2113536
    v_add_u32 v94, 1024, v90
    v_add_u32 v6, 11, v2
    v_mul_u32_u24 v6, 37, v6
    v_add_u32 v6, s56, v6
    v_and_b32 v7, 3, v6
    v_lshlrev_b32 v7, v7, 1
    v_bfe_i32 v80, v6, 2, 1
    v_and_b32 v80, 15, v80
    v_xor_b32 v7, v7, v80
    v_bfe_u32 v6, v6, 3, 4
    v_lshl_or_b32 v6, v6, 16, v7
    v_lshrrev_b32 v80, 0, v6
    v_and_b32 v80, 0x10001, v80
    v_lshrrev_b32 v81, 1, v6
    v_and_b32 v81, 0x10001, v81
    v_lshrrev_b32 v82, 2, v6
    v_and_b32 v82, 0x10001, v82
    v_lshrrev_b32 v83, 3, v6
    v_and_b32 v83, 0x10001, v83
    v_mov_b32 v196, s57
    v_mov_b32 v197, s57
    v_mov_b32 v198, s57
    v_mov_b32 v199, s57
L_A_c3:
    s_bfe_u64 s[100:101], s[16:17], s24
    s_add_u32 s24, s24, 4
    v_xor_b32 v6, s100, v1
    v_lshlrev_b32 v6, 4, v6
    buffer_load_dwordx4 v6, s[36:39], s88 offen nt lds
    s_addk_i32 m0, 0x400
    s_addk_i32 s88, 0x400
    s_cmp_lt_u32 s24, 262272
    s_cbranch_scc1 L_A_c3
    s_mov_b64 exec, 0xff
    buffer_store_dwordx4 v[196:199], v4, s[32:35], s93 offen sc1
    s_mov_b64 exec, -1
    s_getpc_b64 s[100:101]
L_pf1:
    v_lshrrev_b32 v6, 2, v0
    v_lshlrev_b32 v6, 7, v6
    v_min_u32 v6, L_A_done-L_pf1, v6
    v_add_u32 v6, L_pf1-L_pf1, v6
    s_mov_b32 exec_lo, 0x11111111
    s_mov_b32 exec_hi, 0x11111111
    global_load_dword v9, v6, s[100:101]
    s_mov_b64 exec, -1
    s_waitcnt vmcnt(4)
    s_barrier
    v_xor_b32 v6, 0, v78
    s_add_u32 m0, s90, 0
    s_add_u32 s3, s89, 0
    buffer_load_dwordx4 v6, s[32:35], s3 offen sc1 lds
    v_xor_b32 v7, 32, v78
    s_add_u32 m0, s90, 1024
    s_add_u32 s3, s89, 1024
    buffer_load_dwordx4 v7, s[32:35], s3 offen sc1 lds
    v_xor_b32 v6, 16, v78
    s_add_u32 m0, s90, 2048
    s_add_u32 s3, s89, 2048
    buffer_load_dwordx4 v6, s[32:35], s3 offen sc1 lds
    v_xor_b32 v7, 48, v78
    s_add_u32 m0, s90, 3072
    s_add_u32 s3, s89, 3072
    buffer_load_dwordx4 v7, s[32:35], s3 offen sc1 lds
    v_xor_b32 v6, 0, v78
    s_add_u32 m0, s90, 4096
    s_add_u32 s3, s89, 4096
    buffer_load_dwordx4 v6, s[32:35], s3 offen sc1 lds
    v_xor_b32 v7, 32, v78
    s_add_u32 m0, s90, 5120
    s_add_u32 s3, s89, 5120
    buffer_load_dwordx4 v7, s[32:35], s3 offen sc1 lds
    v_xor_b32 v6, 16, v78
    s_add_u32 m0, s90, 6144
    s_add_u32 s3, s89, 6144
    buffer_load_dwordx4 v6, s[32:35], s3 offen sc1 lds
    v_xor_b32 v7, 48, v78
    s_add_u32 m0, s90, 7168
    s_add_u32 s3, s89, 7168
    buffer_load_dwordx4 v7, s[32:35], s3 offen sc1 lds
    buffer_load_dwordx2 v[92:93], v91, s[32:35], s92 offen sc1
    s_waitcnt vmcnt(9)
    s_barrier
    ds_read_b64_tr_b16 a[0:1], v46 offset:0
    ds_read_b64_tr_b16 a[2:3], v47 offset:0
    ds_read_b64_tr_b16 a[4:5], v48 offset:0
    ds_read_b64_tr_b16 a[6:7], v49 offset:0
    ds_read_b64_tr_b16 a[8:9], v50 offset:0
    ds_read_b64_tr_b16 a[10:11], v51 offset:0
    ds_read_b64_tr_b16 a[12:13], v52 offset:0
    ds_read_b64_tr_b16 a[14:15], v53 offset:0
    s_waitcnt lgkmcnt(6)
    ds_read_b64_tr_b16 a[16:17], v54 offset:0
    ds_read_b64_tr_b16 a[18:19], v55 offset:0
    ds_read_b64_tr_b16 a[20:21], v56 offset:0
    ds_read_b64_tr_b16 a[22:23], v57 offset:0
    ds_read_b64_tr_b16 a[24:25], v58 offset:0
    ds_read_b64_tr_b16 a[26:27], v59 offset:0
    ds_read_b64_tr_b16 a[28:29], v60 offset:0
    ds_read_b64_tr_b16 a[30:31], v61 offset:0
    s_waitcnt lgkmcnt(6)
    ds_read_b64_tr_b16 a[32:33], v46 offset:32768
    ds_read_b64_tr_b16 a[34:35], v47 offset:32768
    ds_read_b64_tr_b16 a[36:37], v48 offset:32768
    ds_read_b64_tr_b16 a[38:39], v49 offset:32768
    ds_read_b64_tr_b16 a[40:41], v50 offset:32768
    ds_read_b64_tr_b16 a[42:43], v51 offset:32768
    ds_read_b64_tr_b16 a[44:45], v52 offset:32768
    ds_read_b64_tr_b16 a[46:47], v53 offset:32768
    s_waitcnt lgkmcnt(6)
    ds_read_b64_tr_b16 a[48:49], v54 offset:32768
    ds_read_b64_tr_b16 a[50:51], v55 offset:32768
    ds_read_b64_tr_b16 a[52:53], v56 offset:32768
    ds_read_b64_tr_b16 a[54:55], v57 offset:32768
    ds_read_b64_tr_b16 a[56:57], v58 offset:32768
    ds_read_b64_tr_b16 a[58:59], v59 offset:32768
    ds_read_b64_tr_b16 a[60:61], v60 offset:32768
    ds_read_b64_tr_b16 a[62:63], v61 offset:32768
    s_waitcnt lgkmcnt(6)
    ds_read_b64_tr_b16 a[64:65], v62 offset:0
    ds_read_b64_tr_b16 a[66:67], v63 offset:0
    ds_read_b64_tr_b16 a[68:69], v64 offset:0
    ds_read_b64_tr_b16 a[70:71], v65 offset:0
    ds_read_b64_tr_b16 a[72:73], v66 offset:0
    ds_read_b64_tr_b16 a[74:75], v67 offset:0
    ds_read_b64_tr_b16 a[76:77], v68 offset:0
    ds_read_b64_tr_b16 a[78:79], v69 offset:0
    s_waitcnt lgkmcnt(6)
    ds_read_b64_tr_b16 a[80:81], v70 offset:0
    ds_read_b64_tr_b16 a[82:83], v71 offset:0
    ds_read_b64_tr_b16 a[84:85], v72 offset:0
    ds_read_b64_tr_b16 a[86:87], v73 offset:0
    ds_read_b64_tr_b16 a[88:89], v74 offset:0
    ds_read_b64_tr_b16 a[90:91], v75 offset:0
    ds_read_b64_tr_b16 a[92:93], v76 offset:0
    ds_read_b64_tr_b16 a[94:95], v77 offset:0
    s_waitcnt lgkmcnt(6)
    ds_read_b64_tr_b16 a[96:97], v62 offset:32768
    ds_read_b64_tr_b16 a[98:99], v63 offset:32768
    ds_read_b64_tr_b16 a[100:101], v64 offset:32768
    ds_read_b64_tr_b16 a[102:103], v65 offset:32768
    ds_read_b64_tr_b16 a[104:105], v66 offset:32768
    ds_read_b64_tr_b16 a[106:107], v67 offset:32768
    ds_read_b64_tr_b16 a[108:109], v68 offset:32768
    ds_read_b64_tr_b16 a[110:111], v69 offset:32768
    s_waitcnt lgkmcnt(6)
    ds_read_b64_tr_b16 a[112:113], v70 offset:32768
    ds_read_b64_tr_b16 a[114:115], v71 offset:32768
    ds_read_b64_tr_b16 a[116:117], v72 offset:32768
    ds_read_b64_tr_b16 a[118:119], v73 offset:32768
    ds_read_b64_tr_b16 a[120:121], v74 offset:32768
    ds_read_b64_tr_b16 a[122:123], v75 offset:32768
    ds_read_b64_tr_b16 a[124:125], v76 offset:32768
    ds_read_b64_tr_b16 a[126:127], v77 offset:32768
    s_waitcnt lgkmcnt(6)
    s_waitcnt lgkmcnt(0)
    s_waitcnt vmcnt(0)
L_A_gw:
    v_cmp_ne_u32 vcc, s57, v93
    s_cbranch_vccnz L_A_ck
L_A_wait:
    s_barrier
    ds_read_b128 v[128:131], v30 offset:0
    ds_read_b128 v[144:147], v38 offset:0
    ds_read_b128 v[132:135], v31 offset:0
    ds_read_b128 v[148:151], v39 offset:0
    ds_read_b128 v[136:139], v32 offset:0
    ds_read_b128 v[152:155], v40 offset:0
    v_mov_b32 v7, 0x7f800000
    s_lshl_b32 s25, s52, 14
    s_lshl_b32 s31, s30, 8
    s_add_u32 s25, s25, s31
    s_lshl_b32 s88, s30, 12
    s_add_u32 s88, s88, 147456
    v_and_b32 v200, 0xff, v78
    v_lshl_or_b32 v200, v3, 10, v200
    v_xor_b32 v201, 32, v200
    ds_read_b128 v[140:143], v33 offset:0
    ds_read_b128 v[156:159], v41 offset:0
    s_waitcnt lgkmcnt(6)
    v_mfma_f32_32x32x16_bf16 v[96:111], v[128:131], v[144:147], 0
    v_add_u32 v112, v144, v145
    v_add3_u32 v112, v112, v146, v147
    ds_read_b128 v[128:131], v34 offset:0
    ds_read_b128 v[144:147], v42 offset:0
    s_waitcnt lgkmcnt(6)
    v_mfma_f32_32x32x16_bf16 v[96:111], v[132:135], v[148:151], v[96:111]
    v_add3_u32 v112, v112, v148, v149
    v_add3_u32 v112, v112, v150, v151
    s_add_u32 s3, s94, 0
    buffer_load_dwordx4 a[128:131], v28, s[40:43], s3 offen nt
    ds_read_b128 v[132:135], v35 offset:0
    ds_read_b128 v[148:151], v43 offset:0
    s_waitcnt lgkmcnt(6)
    v_mfma_f32_32x32x16_bf16 v[96:111], v[136:139], v[152:155], v[96:111]
    v_add3_u32 v112, v112, v152, v153
    v_add3_u32 v112, v112, v154, v155
    ds_read_b128 v[136:139], v36 offset:0
    ds_read_b128 v[152:155], v44 offset:0
    s_waitcnt lgkmcnt(6)
    v_mfma_f32_32x32x16_bf16 v[96:111], v[140:143], v[156:159], v[96:111]
    v_add3_u32 v112, v112, v156, v157
    v_add3_u32 v112, v112, v158, v159
    ds_read_b128 v[140:143], v37 offset:0
    ds_read_b128 v[156:159], v45 offset:0
    s_waitcnt lgkmcnt(6)
    v_mfma_f32_32x32x16_bf16 v[96:111], v[128:131], v[144:147], v[96:111]
    v_add3_u32 v112, v112, v144, v145
    v_add3_u32 v112, v112, v146, v147
    s_add_u32 s3, s94, 0
    buffer_load_dwordx4 a[144:147], v28, s[44:47], s3 offen nt
    ds_read_b128 v[128:131], v30 offset:256
    ds_read_b128 v[144:147], v38 offset:8192
    s_waitcnt lgkmcnt(6)
    v_mfma_f32_32x32x16_bf16 v[96:111], v[132:135], v[148:151], v[96:111]
    v_add3_u32 v112, v112, v148, v149
    v_add3_u32 v112, v112, v150, v151
    ds_read_b128 v[132:135], v31 offset:256
    ds_read_b128 v[148:151], v39 offset:8192
    s_waitcnt lgkmcnt(6)
    v_mfma_f32_32x32x16_bf16 v[96:111], v[136:139], v[152:155], v[96:111]
    v_add3_u32 v112, v112, v152, v153
    v_add3_u32 v112, v112, v154, v155
    ds_read_b128 v[136:139], v32 offset:256
    ds_read_b128 v[152:155], v40 offset:8192
    s_waitcnt lgkmcnt(6)
    v_mfma_f32_32x32x16_bf16 v[96:111], v[140:143], v[156:159], v[96:111]
    v_add3_u32 v112, v112, v156, v157
    v_add3_u32 v112, v112, v158, v159
    s_add_u32 s3, s94, 3584
    buffer_load_dwordx4 a[132:135], v28, s[40:43], s3 offen nt
    ds_read_b128 v[140:143], v33 offset:256
    ds_read_b128 v[156:159], v41 offset:8192
    s_waitcnt lgkmcnt(6)
    v_mfma_f32_32x32x16_bf16 v[96:111], v[128:131], v[144:147], v[96:111]
    v_add_u32 v113, v144, v145
    v_add3_u32 v113, v113, v146, v147
    ds_read_b128 v[128:131], v34 offset:256
    ds_read_b128 v[144:147], v42 offset:8192
    s_waitcnt lgkmcnt(6)
    v_mfma_f32_32x32x16_bf16 v[96:111], v[132:135], v[148:151], v[96:111]
    v_add3_u32 v113, v113, v148, v149
    v_add3_u32 v113, v113, v150, v151
    ds_read_b128 v[132:135], v35 offset:256
    ds_read_b128 v[148:151], v43 offset:8192
    s_waitcnt lgkmcnt(6)
    v_mfma_f32_32x32x16_bf16 v[96:111], v[136:139], v[152:155], v[96:111]
    v_add3_u32 v113, v113, v152, v153
    v_add3_u32 v113, v113, v154, v155
    s_add_u32 s3, s94, 3584
    buffer_load_dwordx4 a[148:151], v28, s[44:47], s3 offen nt
    ds_read_b128 v[136:139], v36 offset:256
    ds_read_b128 v[152:155], v44 offset:8192
    s_waitcnt lgkmcnt(6)
    v_mfma_f32_32x32x16_bf16 v[96:111], v[140:143], v[156:159], v[96:111]
    v_add3_u32 v113, v113, v156, v157
    v_add3_u32 v113, v113, v158, v159
    ds_read_b128 v[140:143], v37 offset:256
    ds_read_b128 v[156:159], v45 offset:8192
    s_waitcnt lgkmcnt(6)
    v_mfma_f32_32x32x16_bf16 v[96:111], v[128:131], v[144:147], v[96:111]
    v_add3_u32 v113, v113, v144, v145
    v_add3_u32 v113, v113, v146, v147
    ds_read_b128 v[128:131], v30 offset:512
    ds_read_b128 v[144:147], v38 offset:16384
    s_waitcnt lgkmcnt(6)
    v_mfma_f32_32x32x16_bf16 v[96:111], v[132:135], v[148:151], v[96:111]
    v_add3_u32 v113, v113, v148, v149
    v_add3_u32 v113, v113, v150, v151
    s_add_u32 s3, s94, 7168
    buffer_load_dwordx4 a[136:139], v28, s[40:43], s3 offen nt
    ds_read_b128 v[132:135], v31 offset:512
    ds_read_b128 v[148:151], v39 offset:16384
    s_waitcnt lgkmcnt(6)
    v_mfma_f32_32x32x16_bf16 v[96:111], v[136:139], v[152:155], v[96:111]
    v_add3_u32 v113, v113, v152, v153
    v_add3_u32 v113, v113, v154, v155
    ds_read_b128 v[136:139], v32 offset:512
    ds_read_b128 v[152:155], v40 offset:16384
    s_waitcnt lgkmcnt(6)
    v_mfma_f32_32x32x16_bf16 v[96:111], v[140:143], v[156:159], v[96:111]
    v_add3_u32 v113, v113, v156, v157
    v_add3_u32 v113, v113, v158, v159
    ds_read_b128 v[140:143], v33 offset:512
    ds_read_b128 v[156:159], v41 offset:16384
    s_waitcnt lgkmcnt(6)
    v_mfma_f32_32x32x16_bf16 v[96:111], v[128:131], v[144:147], v[96:111]
    v_add_u32 v114, v144, v145
    v_add3_u32 v114, v114, v146, v147
    s_add_u32 s3, s94, 7168
    buffer_load_dwordx4 a[152:155], v28, s[44:47], s3 offen nt
    ds_read_b128 v[128:131], v34 offset:512
    ds_read_b128 v[144:147], v42 offset:16384
    s_waitcnt lgkmcnt(6)
    v_mfma_f32_32x32x16_bf16 v[96:111], v[132:135], v[148:151], v[96:111]
    v_add3_u32 v114, v114, v148, v149
    v_add3_u32 v114, v114, v150, v151
    ds_read_b128 v[132:135], v35 offset:512
    ds_read_b128 v[148:151], v43 offset:16384
    s_waitcnt lgkmcnt(6)
    v_mfma_f32_32x32x16_bf16 v[96:111], v[136:139], v[152:155], v[96:111]
    v_add3_u32 v114, v114, v152, v153
    v_add3_u32 v114, v114, v154, v155
    ds_read_b128 v[136:139], v36 offset:512
    ds_read_b128 v[152:155], v44 offset:16384
    s_waitcnt lgkmcnt(6)
    v_mfma_f32_32x32x16_bf16 v[96:111], v[140:143], v[156:159], v[96:111]
    v_add3_u32 v114, v114, v156, v157
    v_add3_u32 v114, v114, v158, v159
    s_add_u32 s3, s94, 10752
    buffer_load_dwordx4 a[140:143], v28, s[40:43], s3 offen nt
    ds_read_b128 v[140:143], v37 offset:512
    ds_read_b128 v[156:159], v45 offset:16384
    s_waitcnt lgkmcnt(6)
    v_mfma_f32_32x32x16_bf16 v[96:111], v[128:131], v[144:147], v[96:111]
    v_add3_u32 v114, v114, v144, v145
    v_add3_u32 v114, v114, v146, v147
    ds_read_b128 v[128:131], v30 offset:768
    ds_read_b128 v[144:147], v38 offset:24576
    s_waitcnt lgkmcnt(6)
    v_mfma_f32_32x32x16_bf16 v[96:111], v[132:135], v[148:151], v[96:111]
    v_add3_u32 v114, v114, v148, v149
    v_add3_u32 v114, v114, v150, v151
    ds_read_b128 v[132:135], v31 offset:768
    ds_read_b128 v[148:151], v39 offset:24576
    s_waitcnt lgkmcnt(6)
    v_mfma_f32_32x32x16_bf16 v[96:111], v[136:139], v[152:155], v[96:111]
    v_add3_u32 v114, v114, v152, v153
    v_add3_u32 v114, v114, v154, v155
    s_add_u32 s3, s94, 10752
    buffer_load_dwordx4 a[156:159], v28, s[44:47], s3 offen nt
    ds_read_b128 v[136:139], v32 offset:768
    ds_read_b128 v[152:155], v40 offset:24576
    s_waitcnt lgkmcnt(6)
    v_mfma_f32_32x32x16_bf16 v[96:111], v[140:143], v[156:159], v[96:111]
    v_add3_u32 v114, v114, v156, v157
    v_add3_u32 v114, v114, v158, v159
    ds_read_b128 v[140:143], v33 offset:768
    ds_read_b128 v[156:159], v41 offset:24576
    s_waitcnt lgkmcnt(6)
    v_mfma_f32_32x32x16_bf16 v[96:111], v[128:131], v[144:147], v[96:111]
    v_add_u32 v115, v144, v145
    v_add3_u32 v115, v115, v146, v147
    s_barrier
    ds_read_b128 v[128:131], v34 offset:768
    ds_read_b128 v[144:147], v42 offset:24576
    s_waitcnt lgkmcnt(6)
    v_mfma_f32_32x32x16_bf16 v[96:111], v[132:135], v[148:151], v[96:111]
    v_add3_u32 v115, v115, v148, v149
    v_add3_u32 v115, v115, v150, v151
    ds_read_b128 v[132:135], v35 offset:768
    ds_read_b128 v[148:151], v43 offset:24576
    s_waitcnt lgkmcnt(6)
    v_mfma_f32_32x32x16_bf16 v[96:111], v[136:139], v[152:155], v[96:111]
    v_add3_u32 v115, v115, v152, v153
    v_add3_u32 v115, v115, v154, v155
    ds_read_b128 v[136:139], v36 offset:768
    ds_read_b128 v[152:155], v44 offset:24576
    s_waitcnt lgkmcnt(6)
    v_mfma_f32_32x32x16_bf16 v[96:111], v[140:143], v[156:159], v[96:111]
    v_add3_u32 v115, v115, v156, v157
    v_add3_u32 v115, v115, v158, v159
    ds_read_b128 v[140:143], v37 offset:768
    ds_read_b128 v[156:159], v45 offset:24576
    s_waitcnt lgkmcnt(6)
    v_mfma_f32_32x32x16_bf16 v[96:111], v[128:131], v[144:147], v[96:111]
    v_add3_u32 v115, v115, v144, v145
    v_add3_u32 v115, v115, v146, v147
    s_waitcnt lgkmcnt(4)
    v_mfma_f32_32x32x16_bf16 v[96:111], v[132:135], v[148:151], v[96:111]
    v_add3_u32 v115, v115, v148, v149
    v_add3_u32 v115, v115, v150, v151
    s_waitcnt lgkmcnt(2)
    v_mfma_f32_32x32x16_bf16 v[96:111], v[136:139], v[152:155], v[96:111]
    v_add3_u32 v115, v115, v152, v153
    v_add3_u32 v115, v115, v154, v155
    s_waitcnt lgkmcnt(0)
    v_mfma_f32_32x32x16_bf16 v[96:111], v[140:143], v[156:159], v[96:111]
    v_add3_u32 v115, v115, v156, v157
    v_add3_u32 v115, v115, v158, v159
    v_cndmask_b32 v112, v112, v113, s[8:9]
    v_cndmask_b32 v112, v112, v114, s[12:13]
    v_cndmask_b32 v112, v112, v115, s[14:15]
    v_mov_b32 v6, v112
    v_mov_b32 v242, s57
    v_mov_b32 v243, s57
    v_permlane32_swap_b32 v112, v6
    v_add_u32 v112, v112, v6
    v_cmp_ne_u32 vcc, v112, v92
    v_lshlrev_b32 v6, 4, v89
    v_max3_f32 v116, v96, v97, v98
    v_max3_f32 v117, v99, v100, v101
    v_max3_f32 v116, v116, v102, v103
    v_max3_f32 v117, v117, v104, v105
    v_max3_f32 v116, v116, v106, v107
    v_max3_f32 v117, v117, v108, v109
    v_max3_f32 v116, v116, v110, v111
    v_max_f32 v116, v116, v117
    v_cndmask_b32 v116, v116, v7, vcc
    ds_write_b32 v86, v116
    s_waitcnt lgkmcnt(0)
    s_barrier
    ds_read_b128 v[128:131], v85
    ds_read_b128 v[132:135], v85 offset:16
    s_add_u32 s22, s22, 1
    s_cmp_lt_u32 s22, 64
    s_waitcnt lgkmcnt(1)
    v_max3_f32 v116, v128, v129, v130
    s_waitcnt lgkmcnt(0)
    v_max3_f32 v117, v132, v133, v134
    v_max3_f32 v116, v116, v131, v135
    v_max_f32 v116, v116, v117
    v_cmp_eq_u32 vcc, v116, v7
    v_mov_b32 v117, v116
    s_cbranch_scc0 L_A_ok
    s_cbranch_vccnz L_A_redo
L_A_ok:
    v_pk_add_f32 v[96:97], v[96:97], v[116:117] neg_lo:[0,1] neg_hi:[0,1]
    v_pk_add_f32 v[98:99], v[98:99], v[116:117] neg_lo:[0,1] neg_hi:[0,1]
    v_pk_add_f32 v[100:101], v[100:101], v[116:117] neg_lo:[0,1] neg_hi:[0,1]
    v_pk_add_f32 v[102:103], v[102:103], v[116:117] neg_lo:[0,1] neg_hi:[0,1]
    v_pk_add_f32 v[104:105], v[104:105], v[116:117] neg_lo:[0,1] neg_hi:[0,1]
    v_pk_add_f32 v[106:107], v[106:107], v[116:117] neg_lo:[0,1] neg_hi:[0,1]
    v_pk_add_f32 v[108:109], v[108:109], v[116:117] neg_lo:[0,1] neg_hi:[0,1]
    v_pk_add_f32 v[110:111], v[110:111], v[116:117] neg_lo:[0,1] neg_hi:[0,1]
    v_exp_f32 v96, v96
    v_exp_f32 v97, v97
    v_exp_f32 v98, v98
    v_exp_f32 v99, v99
    v_exp_f32 v100, v100
    v_exp_f32 v101, v101
    v_exp_f32 v102, v102
    v_exp_f32 v103, v103
    v_cvt_pk_bf16_f32 v136, v96, v97
    v_cvt_pk_bf16_f32 v137, v98, v99
    v_cvt_pk_bf16_f32 v138, v100, v101
    v_cvt_pk_bf16_f32 v139, v102, v103
    ds_write_b128 v87, v[136:139] offset:0
    v_exp_f32 v104, v104
    v_exp_f32 v105, v105
    v_exp_f32 v106, v106
    v_exp_f32 v107, v107
    v_exp_f32 v108, v108
    v_exp_f32 v109, v109
    v_exp_f32 v110, v110
    v_exp_f32 v111, v111
    v_cvt_pk_bf16_f32 v140, v104, v105
    v_cvt_pk_bf16_f32 v141, v106, v107
    v_cvt_pk_bf16_f32 v142, v108, v109
    v_cvt_pk_bf16_f32 v143, v110, v111
    ds_write_b128 v87, v[140:143] offset:512
    v_pk_add_f32 v[96:97], v[96:97], v[104:105]
    v_pk_add_f32 v[98:99], v[98:99], v[106:107]
    v_pk_add_f32 v[100:101], v[100:101], v[108:109]
    v_pk_add_f32 v[102:103], v[102:103], v[110:111]
    v_pk_add_f32 v[96:97], v[96:97], v[100:101]
    v_pk_add_f32 v[98:99], v[98:99], v[102:103]
    v_pk_add_f32 v[96:97], v[96:97], v[98:99]
    v_add_f32 v96, v96, v97
    ds_write_b32 v86, v96 offset:1024
    v_mov_b32 v240, v116
    v_mov_b32 v252, v200
    v_mov_b32 v253, v201
    s_waitcnt lgkmcnt(0)
    s_barrier
    ds_read_b128 v[128:131], v90 offset:0
    ds_read_b128 v[244:247], v85 offset:1024
    ds_read_b128 v[248:251], v85 offset:1040
    s_waitcnt lgkmcnt(2)
    v_mfma_f32_16x16x32_bf16 v[160:163], v[128:131], a[0:3], 0
    v_mfma_f32_16x16x32_bf16 v[164:167], v[128:131], a[4:7], 0
    ds_read_b128 v[132:135], v90 offset:2048
    v_mfma_f32_16x16x32_bf16 v[168:171], v[128:131], a[8:11], 0
    v_mfma_f32_16x16x32_bf16 v[172:175], v[128:131], a[12:15], 0
    s_waitcnt lgkmcnt(1)
    v_mfma_f32_16x16x32_bf16 v[176:179], v[128:131], a[16:19], 0
    v_pk_add_f32 v[244:245], v[244:245], v[246:247]
    v_mfma_f32_16x16x32_bf16 v[180:183], v[128:131], a[20:23], 0
    v_pk_add_f32 v[248:249], v[248:249], v[250:251]
    v_mfma_f32_16x16x32_bf16 v[184:187], v[128:131], a[24:27], 0
    v_pk_add_f32 v[244:245], v[244:245], v[248:249]
    v_mfma_f32_16x16x32_bf16 v[188:191], v[128:131], a[28:31], 0
    v_add_f32 v241, v244, v245
    s_waitcnt lgkmcnt(0)
    v_mfma_f32_16x16x32_bf16 v[160:163], v[132:135], a[32:35], v[160:163]
    s_lshl_b32 exec_lo, 0xff, s97
    s_mov_b32 exec_hi, 0
    buffer_store_dwordx4 v[240:243], v6, s[32:35], s96 offen sc1
    s_mov_b64 exec, -1
    v_mfma_f32_16x16x32_bf16 v[164:167], v[132:135], a[36:39], v[164:167]
    s_lshl_b32 s31, s30, 11
    v_add_u32 v42, s31, v4
    ds_read_b128 v[136:139], v90 offset:4096
    v_mfma_f32_16x16x32_bf16 v[168:171], v[132:135], a[40:43], v[168:171]
    s_and_b32 s3, s30, 1
    s_lshl_b32 s31, s3, 10
    v_mfma_f32_16x16x32_bf16 v[172:175], v[132:135], a[44:47], v[172:175]
    v_add_u32 v43, s31, v4
    v_lshrrev_b32 v44, 1, v2
    v_mfma_f32_16x16x32_bf16 v[176:179], v[132:135], a[48:51], v[176:179]
    v_lshlrev_b32 v44, 11, v44
    v_and_b32 v254, 1, v2
    v_mfma_f32_16x16x32_bf16 v[180:183], v[132:135], a[52:55], v[180:183]
    v_lshl_or_b32 v254, v3, 1, v254
    v_lshl_or_b32 v44, v254, 4, v44
    v_mfma_f32_16x16x32_bf16 v[184:187], v[132:135], a[56:59], v[184:187]
    s_lshl_b32 s89, s52, 11
    s_add_u32 s89, s89, 200704
    v_mfma_f32_16x16x32_bf16 v[188:191], v[132:135], a[60:63], v[188:191]
    s_lshr_b32 s91, s52, 3
    s_lshl_b32 s91, s91, 14
    s_waitcnt lgkmcnt(0)
    v_mfma_f32_16x16x32_bf16 v[160:163], v[136:139], a[64:67], v[160:163]
    s_and_b32 s31, s52, 7
    s_lshl_b32 s31, s31, 8
    v_mfma_f32_16x16x32_bf16 v[164:167], v[136:139], a[68:71], v[164:167]
    s_lshl_b32 s3, s3, 7
    s_add_u32 s31, s31, s3
    ds_read_b128 v[140:143], v90 offset:6144
    v_mfma_f32_16x16x32_bf16 v[168:171], v[136:139], a[72:75], v[168:171]
    s_add_u32 s91, s91, s31
    s_add_u32 s91, s91, 200704
    v_mfma_f32_16x16x32_bf16 v[172:175], v[136:139], a[76:79], v[172:175]
    s_cmp_lt_u32 s30, 2
    s_cselect_b32 s31, 112, 0
    v_mfma_f32_16x16x32_bf16 v[176:179], v[136:139], a[80:83], v[176:179]
    s_cmp_lt_u32 s52, s31
    s_cselect_b32 s91, s91, 6291456
    v_mfma_f32_16x16x32_bf16 v[180:183], v[136:139], a[84:87], v[180:183]
    v_mov_b32 v86, 0xffffff00
    v_lshrrev_b32 v45, 3, v2
    v_mfma_f32_16x16x32_bf16 v[184:187], v[136:139], a[88:91], v[184:187]
    v_lshl_add_u32 v45, v3, 1, v45
    v_mul_u32_u24 v45, 32896, v45
    v_mfma_f32_16x16x32_bf16 v[188:191], v[136:139], a[92:95], v[188:191]
    v_and_b32 v254, 7, v2
    v_lshl_add_u32 v45, v254, 4, v45
    s_waitcnt lgkmcnt(0)
    v_mfma_f32_16x16x32_bf16 v[160:163], v[140:143], a[96:99], v[160:163]
    s_mul_i32 s92, s30, 263168
    s_lshl_b32 s31, s52, 7
    v_mfma_f32_16x16x32_bf16 v[164:167], v[140:143], a[100:103], v[164:167]
    s_add_u32 s92, s92, s31
    s_add_u32 s92, s92, 4767744
    ds_read_b128 v[144:147], v94 offset:0
    v_mfma_f32_16x16x32_bf16 v[168:171], v[140:143], a[104:107], v[168:171]
    ds_read_b128 v[148:151], v94 offset:2048
    v_mfma_f32_16x16x32_bf16 v[172:175], v[140:143], a[108:111], v[172:175]
    ds_read_b128 v[152:155], v94 offset:4096
    v_mfma_f32_16x16x32_bf16 v[176:179], v[140:143], a[112:115], v[176:179]
    ds_read_b128 v[156:159], v94 offset:6144
    v_mfma_f32_16x16x32_bf16 v[180:183], v[140:143], a[116:119], v[180:183]
    v_mfma_f32_16x16x32_bf16 v[184:187], v[140:143], a[120:123], v[184:187]
    v_mfma_f32_16x16x32_bf16 v[188:191], v[140:143], a[124:127], v[188:191]
    s_waitcnt lgkmcnt(3)
    v_mfma_f32_16x16x32_bf16 v[192:195], v[144:147], a[0:3], 0
    v_mfma_f32_16x16x32_bf16 v[196:199], v[144:147], a[4:7], 0
    v_mfma_f32_16x16x32_bf16 v[200:203], v[144:147], a[8:11], 0
    v_mfma_f32_16x16x32_bf16 v[204:207], v[144:147], a[12:15], 0
    v_mfma_f32_16x16x32_bf16 v[208:211], v[144:147], a[16:19], 0
    v_mfma_f32_16x16x32_bf16 v[212:215], v[144:147], a[20:23], 0
    v_mfma_f32_16x16x32_bf16 v[216:219], v[144:147], a[24:27], 0
    v_mfma_f32_16x16x32_bf16 v[220:223], v[144:147], a[28:31], 0
    v_perm_b32 v224, v164, v160, s63
    v_and_or_b32 v224, v224, v84, v80
    s_waitcnt lgkmcnt(2)
    v_mfma_f32_16x16x32_bf16 v[192:195], v[148:151], a[32:35], v[192:195]
    v_perm_b32 v225, v172, v168, s63
    v_mfma_f32_16x16x32_bf16 v[196:199], v[148:151], a[36:39], v[196:199]
    v_and_or_b32 v225, v225, v84, v81
    v_perm_b32 v226, v180, v176, s63
    v_mfma_f32_16x16x32_bf16 v[200:203], v[148:151], a[40:43], v[200:203]
    v_and_or_b32 v226, v226, v84, v82
    v_mfma_f32_16x16x32_bf16 v[204:207], v[148:151], a[44:47], v[204:207]
    v_perm_b32 v227, v188, v184, s63
    v_and_or_b32 v227, v227, v84, v83
    v_mfma_f32_16x16x32_bf16 v[208:211], v[148:151], a[48:51], v[208:211]
    s_add_u32 s3, s95, 0
    buffer_store_dwordx4 v[224:227], v88, s[32:35], s3 offen sc1
    v_mfma_f32_16x16x32_bf16 v[212:215], v[148:151], a[52:55], v[212:215]
    v_perm_b32 v228, v165, v161, s63
    v_and_or_b32 v228, v228, v84, v80
    v_mfma_f32_16x16x32_bf16 v[216:219], v[148:151], a[56:59], v[216:219]
    v_perm_b32 v229, v173, v169, s63
    v_mfma_f32_16x16x32_bf16 v[220:223], v[148:151], a[60:63], v[220:223]
    v_and_or_b32 v229, v229, v84, v81
    v_perm_b32 v230, v181, v177, s63
    s_waitcnt lgkmcnt(1)
    v_mfma_f32_16x16x32_bf16 v[192:195], v[152:155], a[64:67], v[192:195]
    v_and_or_b32 v230, v230, v84, v82
    v_mfma_f32_16x16x32_bf16 v[196:199], v[152:155], a[68:71], v[196:199]
    v_perm_b32 v231, v189, v185, s63
    v_and_or_b32 v231, v231, v84, v83
    v_mfma_f32_16x16x32_bf16 v[200:203], v[152:155], a[72:75], v[200:203]
    s_add_u32 s3, s95, 132096
    buffer_store_dwordx4 v[228:231], v88, s[32:35], s3 offen sc1
    v_mfma_f32_16x16x32_bf16 v[204:207], v[152:155], a[76:79], v[204:207]
    v_perm_b32 v232, v166, v162, s63
    v_and_or_b32 v232, v232, v84, v80
    v_mfma_f32_16x16x32_bf16 v[208:211], v[152:155], a[80:83], v[208:211]
    v_perm_b32 v233, v174, v170, s63
    v_mfma_f32_16x16x32_bf16 v[212:215], v[152:155], a[84:87], v[212:215]
    v_and_or_b32 v233, v233, v84, v81
    v_perm_b32 v234, v182, v178, s63
    v_mfma_f32_16x16x32_bf16 v[216:219], v[152:155], a[88:91], v[216:219]
    v_and_or_b32 v234, v234, v84, v82
    v_mfma_f32_16x16x32_bf16 v[220:223], v[152:155], a[92:95], v[220:223]
    v_perm_b32 v235, v190, v186, s63
    v_and_or_b32 v235, v235, v84, v83
    s_waitcnt lgkmcnt(0)
    v_mfma_f32_16x16x32_bf16 v[192:195], v[156:159], a[96:99], v[192:195]
    s_add_u32 s3, s95, 264192
    buffer_store_dwordx4 v[232:235], v88, s[32:35], s3 offen sc1
    v_mfma_f32_16x16x32_bf16 v[196:199], v[156:159], a[100:103], v[196:199]
    v_perm_b32 v236, v167, v163, s63
    v_and_or_b32 v236, v236, v84, v80
    v_mfma_f32_16x16x32_bf16 v[200:203], v[156:159], a[104:107], v[200:203]
    v_perm_b32 v237, v175, v171, s63
    v_mfma_f32_16x16x32_bf16 v[204:207], v[156:159], a[108:111], v[204:207]
    v_and_or_b32 v237, v237, v84, v81
    v_perm_b32 v238, v183, v179, s63
    v_mfma_f32_16x16x32_bf16 v[208:211], v[156:159], a[112:115], v[208:211]
    v_and_or_b32 v238, v238, v84, v82
    v_mfma_f32_16x16x32_bf16 v[212:215], v[156:159], a[116:119], v[212:215]
    v_perm_b32 v239, v191, v187, s63
    v_and_or_b32 v239, v239, v84, v83
    v_mfma_f32_16x16x32_bf16 v[216:219], v[156:159], a[120:123], v[216:219]
    s_add_u32 s3, s95, 396288
    buffer_store_dwordx4 v[236:239], v88, s[32:35], s3 offen sc1
    v_mfma_f32_16x16x32_bf16 v[220:223], v[156:159], a[124:127], v[220:223]
    v_perm_b32 v224, v196, v192, s63
    v_and_or_b32 v224, v224, v84, v80
    v_perm_b32 v225, v204, v200, s63
    v_and_or_b32 v225, v225, v84, v81
    v_perm_b32 v226, v212, v208, s63
    v_and_or_b32 v226, v226, v84, v82
    s_nop 1
    v_perm_b32 v227, v220, v216, s63
    v_and_or_b32 v227, v227, v84, v83
    s_add_u32 s3, s23, 0
    buffer_store_dwordx4 v[224:227], v88, s[32:35], s3 offen sc1
    v_perm_b32 v228, v197, v193, s63
    v_and_or_b32 v228, v228, v84, v80
    v_perm_b32 v229, v205, v201, s63
    v_and_or_b32 v229, v229, v84, v81
    v_perm_b32 v230, v213, v209, s63
    v_and_or_b32 v230, v230, v84, v82
    v_perm_b32 v231, v221, v217, s63
    v_and_or_b32 v231, v231, v84, v83
    s_add_u32 s3, s23, 132096
    buffer_store_dwordx4 v[228:231], v88, s[32:35], s3 offen sc1
    v_perm_b32 v232, v198, v194, s63
    v_and_or_b32 v232, v232, v84, v80
    v_perm_b32 v233, v206, v202, s63
    v_and_or_b32 v233, v233, v84, v81
    v_perm_b32 v234, v214, v210, s63
    v_and_or_b32 v234, v234, v84, v82
    v_perm_b32 v235, v222, v218, s63
    v_and_or_b32 v235, v235, v84, v83
    s_add_u32 s3, s23, 264192
    buffer_store_dwordx4 v[232:235], v88, s[32:35], s3 offen sc1
    v_perm_b32 v236, v199, v195, s63
    v_and_or_b32 v236, v236, v84, v80
    v_perm_b32 v237, v207, v203, s63
    v_and_or_b32 v237, v237, v84, v81
    v_perm_b32 v238, v215, v211, s63
    v_and_or_b32 v238, v238, v84, v82
    v_perm_b32 v239, v223, v219, s63
    v_and_or_b32 v239, v239, v84, v83
    s_add_u32 s3, s23, 396288
    buffer_store_dwordx4 v[236:239], v88, s[32:35], s3 offen sc1
    s_cmp_ge_u32 s52, 112
    s_cbranch_scc1 L_A_done
    s_waitcnt vmcnt(9)
    v_mfma_f32_16x16x32_bf16 v[96:99], v[12:15], a[128:131], 0
    v_mfma_f32_16x16x32_bf16 v[100:103], v[12:15], a[144:147], 0
    v_mfma_f32_16x16x32_bf16 v[96:99], v[16:19], a[132:135], v[96:99]
    v_mfma_f32_16x16x32_bf16 v[100:103], v[16:19], a[148:151], v[100:103]
    v_mfma_f32_16x16x32_bf16 v[96:99], v[20:23], a[136:139], v[96:99]
    v_mfma_f32_16x16x32_bf16 v[100:103], v[20:23], a[152:155], v[100:103]
    v_mfma_f32_16x16x32_bf16 v[96:99], v[24:27], a[140:143], v[96:99]
    v_mfma_f32_16x16x32_bf16 v[100:103], v[24:27], a[156:159], v[100:103]
    s_nop 6
    ds_write_b128 v42, v[96:99]
    ds_write_b128 v42, v[100:103] offset:1024
    s_waitcnt lgkmcnt(0)
    s_barrier
    ds_read_b128 v[96:99], v43 offset:0
    ds_read_b128 v[100:103], v43 offset:2048
    ds_read_b128 v[104:107], v43 offset:4096
    ds_read_b128 v[108:111], v43 offset:6144
    s_waitcnt lgkmcnt(0)
    v_pk_add_f32 v[96:97], v[96:97], v[100:101]
    v_pk_add_f32 v[104:105], v[104:105], v[108:109]
    v_pk_add_f32 v[98:99], v[98:99], v[102:103]
    v_pk_add_f32 v[106:107], v[106:107], v[110:111]
    v_pk_add_f32 v[96:97], v[96:97], v[104:105]
    v_pk_add_f32 v[98:99], v[98:99], v[106:107]
    v_and_or_b32 v96, v96, v86, s58
    v_and_or_b32 v97, v97, v86, s59
    v_and_or_b32 v98, v98, v86, s60
    v_and_or_b32 v99, v99, v86, s61
    buffer_store_dwordx4 v[96:99], v44, s[32:35], s91 offen sc1
    s_add_u32 m0, s88, 0
    s_add_u32 s3, s25, 0
    buffer_load_dwordx4 v252, s[48:51], s3 offen nt lds
    s_add_u32 m0, s88, 1024
    s_add_u32 s3, s25, 4096
    buffer_load_dwordx4 v253, s[48:51], s3 offen nt lds
    s_add_u32 m0, s88, 2048
    s_add_u32 s3, s25, 8192
    buffer_load_dwordx4 v252, s[48:51], s3 offen nt lds
    s_add_u32 m0, s88, 3072
    s_add_u32 s3, s25, 12288
    buffer_load_dwordx4 v253, s[48:51], s3 offen nt lds
    v_bfe_u32 v254, v1, 2, 2
    v_lshlrev_b32 v255, 2, v254
    v_and_b32 v30, 1, v3
    v_lshl_or_b32 v255, v30, 1, v255
    v_bfe_u32 v30, v1, 1, 1
    v_xor_b32 v255, v255, v30
    v_lshlrev_b32 v255, 4, v255
    v_lshlrev_b32 v254, 8, v254
    v_lshl_or_b32 v254, v3, 10, v254
    v_and_b32 v30, 1, v1
    v_lshl_or_b32 v254, v30, 3, v254
    v_add_u32 v254, s88, v254
    v_xor_b32 v30, 0, v255
    v_add_u32 v30, v30, v254
    v_xor_b32 v31, 32, v255
    v_add_u32 v31, v31, v254
    v_xor_b32 v32, 64, v255
    v_add_u32 v32, v32, v254
    v_xor_b32 v33, 96, v255
    v_add_u32 v33, v33, v254
    v_xor_b32 v34, 128, v255
    v_add_u32 v34, v34, v254
    v_xor_b32 v35, 160, v255
    v_add_u32 v35, v35, v254
    v_xor_b32 v36, 192, v255
    v_add_u32 v36, v36, v254
    v_xor_b32 v37, 224, v255
    v_add_u32 v37, v37, v254
    v_bfe_u32 v87, v1, 2, 1
    v_lshlrev_b32 v87, 5, v87
    v_and_b32 v254, 1, v1
    v_lshl_or_b32 v87, v254, 4, v87
    v_bfe_u32 v255, v1, 1, 1
    v_lshl_or_b32 v87, v255, 3, v87
    v_lshrrev_b32 v255, 5, v1
    v_lshl_or_b32 v87, v255, 1, v87
    v_and_b32 v255, 1, v3
    v_lshl_or_b32 v87, v255, 2, v87
    s_lshl_b32 s31, s30, 7
    s_add_u32 s31, s31, 135168
    v_add_u32 v87, s31, v87
    v_lshlrev_b32 v254, 5, v254
    v_lshl_add_u32 v254, v3, 3, v254
    v_add_u32 v254, s31, v254
    s_add_u32 s31, s31, 64
    v_mov_b32 v41, s31
    v_mov_b32 v144, 0
    v_mov_b32 v145, 0
    ds_write_b64 v41, v[144:145]
    v_lshrrev_b32 v255, 2, v2
    v_cmp_eq_u32 vcc, 0, v255
    s_nop 1
    v_cndmask_b32 v38, v41, v254, vcc
    v_cmp_eq_u32 vcc, 1, v255
    s_nop 1
    v_cndmask_b32 v39, v41, v254, vcc
    v_cmp_eq_u32 vcc, 2, v255
    s_nop 1
    v_cndmask_b32 v40, v41, v254, vcc
    v_cmp_eq_u32 vcc, 3, v255
    s_nop 1
    v_cndmask_b32 v41, v41, v254, vcc
    s_mov_b32 s62, 0
    v_mov_b32 v144, 0
    v_mov_b32 v145, 0
    v_mov_b32 v146, 0
    v_mov_b32 v147, 0
    v_mov_b32 v148, 0
    v_mov_b32 v149, 0
    v_mov_b32 v150, 0
    v_mov_b32 v151, 0
    s_waitcnt vmcnt(0)
    ds_read_b64_tr_b16 v[128:129], v30
    ds_read_b64_tr_b16 v[130:131], v31
    ds_read_b64_tr_b16 v[132:133], v32
    ds_read_b64_tr_b16 v[134:135], v33
    ds_read_b64_tr_b16 v[136:137], v34
    ds_read_b64_tr_b16 v[138:139], v35
    ds_read_b64_tr_b16 v[140:141], v36
    ds_read_b64_tr_b16 v[142:143], v37
    s_barrier
L_A_gu:
    buffer_load_dwordx4 v[104:107], v4, s[32:35], s89 offen sc1
    buffer_load_dwordx4 v[108:111], v4, s[32:35], s89 offen offset:1024 sc1
L_A_gu1:
    s_add_u32 s62, s62, 1
    s_cmp_lt_u32 s62, 120000
    s_waitcnt vmcnt(0)
    v_xor_b32 v104, s58, v104
    v_xor_b32 v105, s59, v105
    v_xor_b32 v106, s60, v106
    v_xor_b32 v107, s61, v107
    v_xor_b32 v108, s58, v108
    v_xor_b32 v109, s59, v109
    v_xor_b32 v110, s60, v110
    v_xor_b32 v111, s61, v111
    v_or3_b32 v254, v104, v105, v106
    v_or3_b32 v255, v107, v108, v109
    v_or3_b32 v254, v254, v110, v111
    v_bitop3_b32 v254, v254, v255, v86 bitop3:0x54
    v_cmp_ne_u32 vcc, 0, v254
    v_pk_add_f32 v[104:105], v[104:105], v[108:109]
    v_pk_add_f32 v[106:107], v[106:107], v[110:111]
    s_cbranch_scc0 L_A_guok
    s_cbranch_vccnz L_A_gu
L_A_guok:
    v_permlane16_swap_b32 v104, v106
    v_permlane16_swap_b32 v105, v107
    v_add_f32 v104, v104, v106
    v_add_f32 v105, v105, v107
    s_nop 1
    v_permlane32_swap_b32 v104, v105
    v_add_f32 v104, v104, v105
    v_cvt_pk_bf16_f32 v104, v104, v104
    v_and_b32 v104, 0xffff0000, v104
    s_nop 1
    v_mul_f32_dpp v104, v104, v104 row_ror:8 row_mask:0xf bank_mask:0xf
    v_cvt_pk_bf16_f32 v104, v104, v104
    ds_write_b16 v87, v104
    s_waitcnt lgkmcnt(0)
    ds_read_b64 v[152:153], v38
    ds_read_b64 v[154:155], v39
    ds_read_b64 v[156:157], v40
    ds_read_b64 v[158:159], v41
    s_waitcnt lgkmcnt(3)
    v_mfma_f32_16x16x16_bf16 v[144:147], v[152:153], v[128:129], v[144:147]
    v_mfma_f32_16x16x16_bf16 v[148:151], v[152:153], v[130:131], v[148:151]
    s_waitcnt lgkmcnt(2)
    v_mfma_f32_16x16x16_bf16 v[144:147], v[154:155], v[132:133], v[144:147]
    v_mfma_f32_16x16x16_bf16 v[148:151], v[154:155], v[134:135], v[148:151]
    s_waitcnt lgkmcnt(1)
    v_mfma_f32_16x16x16_bf16 v[144:147], v[156:157], v[136:137], v[144:147]
    v_mfma_f32_16x16x16_bf16 v[148:151], v[156:157], v[138:139], v[148:151]
    s_waitcnt lgkmcnt(0)
    v_mfma_f32_16x16x16_bf16 v[144:147], v[158:159], v[140:141], v[144:147]
    v_mfma_f32_16x16x16_bf16 v[148:151], v[158:159], v[142:143], v[148:151]
    s_nop 6
    v_and_or_b32 v104, v144, v86, s58
    v_and_or_b32 v105, v145, v86, s59
    v_and_or_b32 v106, v148, v86, s60
    v_and_or_b32 v107, v149, v86, s61
    buffer_store_dwordx4 v[104:107], v45, s[32:35], s92 offen sc1
L_A_done:
    s_endpgm
L_A_redo:
    s_barrier
L_A_g2:
    v_xor_b32 v6, 0, v78
    s_add_u32 m0, s90, 0
    s_add_u32 s3, s89, 0
    buffer_load_dwordx4 v6, s[32:35], s3 offen sc1 lds
    v_xor_b32 v7, 32, v78
    s_add_u32 m0, s90, 1024
    s_add_u32 s3, s89, 1024
    buffer_load_dwordx4 v7, s[32:35], s3 offen sc1 lds
    v_xor_b32 v6, 16, v78
    s_add_u32 m0, s90, 2048
    s_add_u32 s3, s89, 2048
    buffer_load_dwordx4 v6, s[32:35], s3 offen sc1 lds
    v_xor_b32 v7, 48, v78
    s_add_u32 m0, s90, 3072
    s_add_u32 s3, s89, 3072
    buffer_load_dwordx4 v7, s[32:35], s3 offen sc1 lds
    v_xor_b32 v6, 0, v78
    s_add_u32 m0, s90, 4096
    s_add_u32 s3, s89, 4096
    buffer_load_dwordx4 v6, s[32:35], s3 offen sc1 lds
    v_xor_b32 v7, 32, v78
    s_add_u32 m0, s90, 5120
    s_add_u32 s3, s89, 5120
    buffer_load_dwordx4 v7, s[32:35], s3 offen sc1 lds
    v_xor_b32 v6, 16, v78
    s_add_u32 m0, s90, 6144
    s_add_u32 s3, s89, 6144
    buffer_load_dwordx4 v6, s[32:35], s3 offen sc1 lds
    v_xor_b32 v7, 48, v78
    s_add_u32 m0, s90, 7168
    s_add_u32 s3, s89, 7168
    buffer_load_dwordx4 v7, s[32:35], s3 offen sc1 lds
    buffer_load_dwordx2 v[92:93], v91, s[32:35], s92 offen sc1
    s_waitcnt vmcnt(0)
    s_branch L_A_gw
L_A_ck:
    buffer_load_dwordx2 v[92:93], v91, s[32:35], s92 offen sc1
    s_add_u32 s62, s62, 1
    s_cmp_lt_u32 s62, 30000
    s_waitcnt vmcnt(0)
    s_cbranch_scc0 L_A_wait
    v_cmp_ne_u32 vcc, s57, v93
    s_cbranch_vccnz L_A_ck
    s_branch L_A_g2
L_fin:
L_end:
    s_endpgm
.section .rodata,"a"
.p2align 6
.amdhsa_kernel parallel_sum__compressed_kv_cla__glu_gated_bilinear__decode_kernel
  .amdhsa_next_free_vgpr 512
  .amdhsa_next_free_sgpr 102
  .amdhsa_accum_offset 256
  .amdhsa_group_segment_fixed_size 0
  .amdhsa_kernarg_size 104
  .amdhsa_user_sgpr_count 2
  .amdhsa_user_sgpr_kernarg_segment_ptr 1
  .amdhsa_system_sgpr_workgroup_id_x 1
  .amdhsa_float_denorm_mode_32 3
.end_amdhsa_kernel
```
